```python
import torch

def _softmax(x, axis=-1):
    return torch.softmax(x, dim=axis)
def _gelu(x):
    return torch.nn.functional.gelu(x, approximate="tanh")
def _silu(x):
    return torch.nn.functional.silu(x)
def _sigmoid(x):
    return torch.sigmoid(x)
def _layernorm(x, axis=-1, eps=1e-5):
    m = x.mean(dim=axis, keepdim=True)
    v = x.var(dim=axis, keepdim=True, unbiased=False)
    return (x - m) / torch.sqrt(v + eps)
def _scatter_add(tgt, idx, src, axis=0):
    return tgt.clone().index_add_(axis, idx, src)
def _segment_sum(src, seg, n):
    out = torch.zeros((n,) + src.shape[1:], dtype=src.dtype)
    return out.index_add_(0, seg, src)
def _pad(x, pw):
    flat = tuple(v for pair in reversed(pw) for v in pair)
    return torch.nn.functional.pad(x, flat)

kernel_name = 'standalone__kv_cache_quant_int4_int2_kv_with_per_channel_or_per_token_scales__sampling'

def setup_inputs():

    _w = (lambda a: (lambda t: t.to(torch.bfloat16) if t.is_floating_point() else t)(torch.as_tensor(a)))
    B = 16
    Sq = 16
    Skv = 4096
    Hq = 32
    Hkv = 4
    Dh = 128
    bits = 2
    G = 32
    if G <= 0 or G >= Skv:
        G = max(1, Skv // 2)
    Skv = (Skv // G) * G
    ngk = Skv // G
    qmax = (1 << bits) - 1
    return {
        "q": _w((lambda *s: torch.randn(*s, dtype=torch.bfloat16) * 3.2)(B, Hq, Sq, Dh)),
        "qk": _w(torch.randint(0, qmax + 1, (B, Hkv, Skv, Dh)).to(torch.int32)),
        "qv": _w(torch.randint(0, qmax + 1, (B, Hkv, Skv, Dh)).to(torch.int32)),
        "k_scales": _w(torch.abs((lambda *s: torch.randn(*s, dtype=torch.bfloat16) * 3.2)(B, Hkv, ngk, Dh)) * 0.05 + 0.02),
        "k_zeros": _w((lambda *s: torch.randn(*s, dtype=torch.bfloat16) * 3.2)(B, Hkv, ngk, Dh) + float(qmax) / 2.0),
        "v_scales": _w(torch.abs((lambda *s: torch.randn(*s, dtype=torch.bfloat16) * 0.05)(B, Hkv, Skv, 1)) * 0.05 + 0.02),
        "v_zeros": _w((lambda *s: torch.randn(*s, dtype=torch.bfloat16) * 0.05)(B, Hkv, Skv, 1) + float(qmax) / 2.0),
    }

def reference(q, qk, qv, k_scales, k_zeros, v_scales, v_zeros):
    B, Hq, Sq, Dh = q.shape
    Hkv, Skv = qk.shape[1], qk.shape[2]
    ngk = k_scales.shape[2]
    G = Skv // ngk
    ks = (lambda x, n, axis: torch.repeat_interleave(x, n, dim=axis))(k_scales, G, axis=2)
    kz = (lambda x, n, axis: torch.repeat_interleave(x, n, dim=axis))(k_zeros, G, axis=2)
    k = ((lambda x, dt: x.to(dt))(qk, q.dtype) - kz) * ks
    v = ((lambda x, dt: x.to(dt))(qv, q.dtype) - v_zeros) * v_scales
    rep = Hq // Hkv
    if rep > 1:
        k = (lambda x, n, axis: torch.repeat_interleave(x, n, dim=axis))(k, rep, axis=1)
        v = (lambda x, n, axis: torch.repeat_interleave(x, n, dim=axis))(v, rep, axis=1)
    scale = float(Dh) ** -0.5
    logits = torch.einsum("bhqd,bhkd->bhqk", q, k) * scale
    p = _softmax(logits, axis=-1)
    o = torch.einsum("bhqk,bhkd->bhqd", p, v)
    return o
```

```asm
; @launch grid=(256,1,1) block=(512,1,1) lds=67648
.amdgcn_target "amdgcn-amd-amdhsa--gfx950"
.text
.globl standalone__kv_cache_quant_int4_int2_kv_with_per_channel_or_per_token_scales__sampling_kernel
.p2align 8
.type standalone__kv_cache_quant_int4_int2_kv_with_per_channel_or_per_token_scales__sampling_kernel,@function
standalone__kv_cache_quant_int4_int2_kv_with_per_channel_or_per_token_scales__sampling_kernel:
    s_cmp_ge_u32 s2, 256
    s_cbranch_scc1 L_exit
    s_load_dwordx16 s[40:55], s[0:1], 0
    s_load_dwordx4 s[56:59], s[0:1], 64
    v_lshrrev_b32 v1, 6, v0
    s_lshr_b32 s4, s2, 3
    v_readfirstlane_b32 s3, v1
    s_and_b32 s5, s2, 1
    s_lshr_b32 s6, s4, s5
    s_and_b32 s6, s6, 1
    s_add_u32 s7, s6, 1
    s_lshr_b32 s7, s2, s7
    s_sub_u32 s6, 2, s6
    s_lshr_b32 s6, s2, s6
    s_and_b32 s6, s6, 1
    s_lshr_b32 s60, s4, 2
    s_and_b32 s60, s60, s5
    s_xor_b32 s7, s7, s60
    s_and_b32 s7, s7, 1
    s_lshl_b32 s4, s4, 1
    s_or_b32 s4, s4, s7
    s_lshl_b32 s6, s6, 1
    s_or_b32 s5, s5, s6
    s_cmp_lt_u32 s3, 4
    s_cbranch_scc1 L_consumer
    s_sub_u32 s3, s3, 4
    v_and_b32 v6, 31, v0
    v_bfe_u32 v7, v0, 5, 1
    v_lshlrev_b32 v1, 4, v6
    v_lshl_add_u32 v1, v7, 9, v1
    v_add_u32 v188, 0x1000, v1
    v_mov_b32 v189, 0x01000c0c
    v_lshlrev_b32 v187, 1, v7
    v_lshlrev_b32 v186, 16, v187
    v_lshl_add_u32 v186, v187, 24, v186
    v_add_u32 v189, v189, v186
    v_lshlrev_b32 v2, 3, v6
    v_lshlrev_b32 v3, 4, v7
    s_lshl_b32 s68, s4, 21
    s_lshl_b32 s69, s4, 15
    s_lshl_b32 s70, s4, 13
    s_lshl_b32 s87, s5, 2
    s_add_u32 s38, s87, s3
    s_add_u32 s87, s87, 0x400
    s_lshl_b32 s32, s38, 13
    s_lshr_b32 s34, s38, 1
    s_lshl_b32 s34, s34, 8
    s_lshl_b32 s33, s38, 13
    s_lshl_b32 s35, s38, 5
    s_mov_b32 s10, 0x200000
    s_mov_b32 s11, 0x20000
    s_mov_b32 s14, 0x200000
    s_mov_b32 s15, 0x20000
    s_mov_b32 s18, 0x8000
    s_mov_b32 s19, 0x20000
    s_mov_b32 s22, 0x8000
    s_mov_b32 s23, 0x20000
    s_mov_b32 s26, 0x2000
    s_mov_b32 s27, 0x20000
    s_mov_b32 s30, 0x2000
    s_mov_b32 s31, 0x20000
    s_waitcnt lgkmcnt(0)
    s_add_u32 s8, s42, s68
    s_addc_u32 s9, s43, 0
    s_add_u32 s16, s46, s69
    s_addc_u32 s17, s47, 0
    s_add_u32 s20, s48, s69
    s_addc_u32 s21, s49, 0
    buffer_load_dwordx2 v[32:33], v2, s[16:19], s34 offen nt
    buffer_load_dwordx2 v[34:35], v2, s[20:23], s34 offen nt
    buffer_load_dwordx4 v[36:39], v1, s[8:11], s32 offen offset:0 nt
    buffer_load_dwordx4 v[40:43], v1, s[8:11], s32 offen offset:1024 nt
    buffer_load_dwordx4 v[44:47], v1, s[8:11], s32 offen offset:2048 nt
    buffer_load_dwordx4 v[48:51], v1, s[8:11], s32 offen offset:3072 nt
    buffer_load_dwordx4 v[52:55], v188, s[8:11], s32 offen offset:0 nt
    buffer_load_dwordx4 v[56:59], v188, s[8:11], s32 offen offset:1024 nt
    buffer_load_dwordx4 v[60:63], v188, s[8:11], s32 offen offset:2048 nt
    buffer_load_dwordx4 v[64:67], v188, s[8:11], s32 offen offset:3072 nt
    s_add_u32 s12, s44, s68
    s_addc_u32 s13, s45, 0
    s_add_u32 s24, s50, s70
    s_addc_u32 s25, s51, 0
    s_add_u32 s28, s52, s70
    s_addc_u32 s29, s53, 0
    buffer_load_dwordx4 v[68:71], v3, s[24:27], s35 offen nt
    buffer_load_dwordx4 v[76:79], v3, s[28:31], s35 offen nt
    buffer_load_dwordx4 v[84:87], v1, s[12:15], s33 offen offset:0 nt
    buffer_load_dwordx4 v[88:91], v1, s[12:15], s33 offen offset:1024 nt
    buffer_load_dwordx4 v[92:95], v1, s[12:15], s33 offen offset:2048 nt
    buffer_load_dwordx4 v[96:99], v1, s[12:15], s33 offen offset:3072 nt
    buffer_load_dwordx4 v[100:103], v188, s[12:15], s33 offen offset:0 nt
    buffer_load_dwordx4 v[104:107], v188, s[12:15], s33 offen offset:1024 nt
    buffer_load_dwordx4 v[108:111], v188, s[12:15], s33 offen offset:2048 nt
    buffer_load_dwordx4 v[112:115], v188, s[12:15], s33 offen offset:3072 nt
    s_mul_i32 s39, s3, 4352
    v_mul_u32_u24 v4, 1088, v7
    v_add3_u32 v4, v4, v2, s39
    v_and_b32 v5, 63, v0
    v_lshlrev_b32 v5, 4, v5
    s_lshl_b32 s39, s3, 12
    s_add_u32 s39, s39, 17408
    v_add_u32 v5, s39, v5
    s_mov_b32 s39, 33824
    v_mov_b32 v6, 33792
    s_mov_b32 s36, 0x3e0293ee
    s_lshl_b32 s68, s4, 10
    s_add_u32 s68, s68, 0x900000
    s_add_u32 s76, s58, s68
    s_addc_u32 s77, s59, 0
    s_mov_b32 s84, 0
    s_mov_b32 s85, 0
    s_mov_b32 s86, 6
    s_cmp_eq_u32 s3, 0
    s_cselect_b32 s86, s86, 0x7fff
    s_mov_b32 s82, 4
    s_mov_b32 s83, 0
    v_mov_b32 v7, -1
    ds_write_b32 v6, v7
    ds_write_b32 v6, v7 offset:33824
    s_add_u32 s87, s87, 16
    s_add_u32 s38, s38, 16
    s_lshl_b32 s32, s38, 13
    s_lshr_b32 s34, s38, 1
    s_lshl_b32 s34, s34, 8
    s_lshl_b32 s33, s38, 13
    s_lshl_b32 s35, s38, 5
    s_waitcnt vmcnt(10)
    v_lshlrev_b32 v8, 16, v32
    v_and_b32 v9, 0xffff0000, v32
    v_lshlrev_b32 v10, 16, v33
    v_and_b32 v11, 0xffff0000, v33
    v_lshlrev_b32 v16, 16, v34
    v_and_b32 v17, 0xffff0000, v34
    v_lshlrev_b32 v18, 16, v35
    v_and_b32 v19, 0xffff0000, v35
    v_mul_f32 v8, s36, v8
    v_mul_f32 v9, s36, v9
    v_mul_f32 v10, s36, v10
    v_mul_f32 v11, s36, v11
    v_mul_f32_e64 v16, -v16, v8
    v_mul_f32_e64 v17, -v17, v9
    v_mul_f32_e64 v18, -v18, v10
    v_mul_f32_e64 v19, -v19, v11
    v_cvt_f32_i32 v36, v36
    v_cvt_f32_i32 v37, v37
    v_cvt_f32_i32 v38, v38
    v_cvt_f32_i32 v39, v39
    v_fma_f32 v36, v36, v8, v16
    v_fma_f32 v37, v37, v9, v17
    v_fma_f32 v38, v38, v10, v18
    v_fma_f32 v39, v39, v11, v19
    v_cvt_pk_bf16_f32 v24, v36, v37
    v_cvt_pk_bf16_f32 v25, v38, v39
    ds_write_b64 v4, v[24:25] offset:0
    v_cvt_f32_i32 v40, v40
    v_cvt_f32_i32 v41, v41
    v_cvt_f32_i32 v42, v42
    v_cvt_f32_i32 v43, v43
    v_fma_f32 v40, v40, v8, v16
    v_fma_f32 v41, v41, v9, v17
    v_fma_f32 v42, v42, v10, v18
    v_fma_f32 v43, v43, v11, v19
    v_cvt_pk_bf16_f32 v26, v40, v41
    v_cvt_pk_bf16_f32 v27, v42, v43
    ds_write_b64 v4, v[26:27] offset:272
    v_cvt_f32_i32 v44, v44
    v_cvt_f32_i32 v45, v45
    v_cvt_f32_i32 v46, v46
    v_cvt_f32_i32 v47, v47
    v_fma_f32 v44, v44, v8, v16
    v_fma_f32 v45, v45, v9, v17
    v_fma_f32 v46, v46, v10, v18
    v_fma_f32 v47, v47, v11, v19
    v_cvt_pk_bf16_f32 v28, v44, v45
    v_cvt_pk_bf16_f32 v29, v46, v47
    ds_write_b64 v4, v[28:29] offset:544
    v_cvt_f32_i32 v48, v48
    v_cvt_f32_i32 v49, v49
    v_cvt_f32_i32 v50, v50
    v_cvt_f32_i32 v51, v51
    v_fma_f32 v48, v48, v8, v16
    v_fma_f32 v49, v49, v9, v17
    v_fma_f32 v50, v50, v10, v18
    v_fma_f32 v51, v51, v11, v19
    v_cvt_pk_bf16_f32 v30, v48, v49
    v_cvt_pk_bf16_f32 v31, v50, v51
    ds_write_b64 v4, v[30:31] offset:816
    v_cvt_f32_i32 v52, v52
    v_cvt_f32_i32 v53, v53
    v_cvt_f32_i32 v54, v54
    v_cvt_f32_i32 v55, v55
    v_fma_f32 v52, v52, v8, v16
    v_fma_f32 v53, v53, v9, v17
    v_fma_f32 v54, v54, v10, v18
    v_fma_f32 v55, v55, v11, v19
    v_cvt_pk_bf16_f32 v24, v52, v53
    v_cvt_pk_bf16_f32 v25, v54, v55
    ds_write_b64 v4, v[24:25] offset:2176
    v_cvt_f32_i32 v56, v56
    v_cvt_f32_i32 v57, v57
    v_cvt_f32_i32 v58, v58
    v_cvt_f32_i32 v59, v59
    v_fma_f32 v56, v56, v8, v16
    v_fma_f32 v57, v57, v9, v17
    v_fma_f32 v58, v58, v10, v18
    v_fma_f32 v59, v59, v11, v19
    v_cvt_pk_bf16_f32 v26, v56, v57
    v_cvt_pk_bf16_f32 v27, v58, v59
    ds_write_b64 v4, v[26:27] offset:2448
    v_cvt_f32_i32 v60, v60
    v_cvt_f32_i32 v61, v61
    v_cvt_f32_i32 v62, v62
    v_cvt_f32_i32 v63, v63
    v_fma_f32 v60, v60, v8, v16
    v_fma_f32 v61, v61, v9, v17
    v_fma_f32 v62, v62, v10, v18
    v_fma_f32 v63, v63, v11, v19
    v_cvt_pk_bf16_f32 v28, v60, v61
    v_cvt_pk_bf16_f32 v29, v62, v63
    ds_write_b64 v4, v[28:29] offset:2720
    v_cvt_f32_i32 v64, v64
    v_cvt_f32_i32 v65, v65
    v_cvt_f32_i32 v66, v66
    v_cvt_f32_i32 v67, v67
    v_fma_f32 v64, v64, v8, v16
    v_fma_f32 v65, v65, v9, v17
    v_fma_f32 v66, v66, v10, v18
    v_fma_f32 v67, v67, v11, v19
    v_cvt_pk_bf16_f32 v30, v64, v65
    v_cvt_pk_bf16_f32 v31, v66, v67
    ds_write_b64 v4, v[30:31] offset:2992
    buffer_load_dwordx2 v[32:33], v2, s[16:19], s34 offen nt
    buffer_load_dwordx2 v[34:35], v2, s[20:23], s34 offen nt
    buffer_load_dwordx4 v[36:39], v1, s[8:11], s32 offen offset:0 nt
    buffer_load_dwordx4 v[40:43], v1, s[8:11], s32 offen offset:1024 nt
    buffer_load_dwordx4 v[44:47], v1, s[8:11], s32 offen offset:2048 nt
    buffer_load_dwordx4 v[48:51], v1, s[8:11], s32 offen offset:3072 nt
    buffer_load_dwordx4 v[52:55], v188, s[8:11], s32 offen offset:0 nt
    buffer_load_dwordx4 v[56:59], v188, s[8:11], s32 offen offset:1024 nt
    buffer_load_dwordx4 v[60:63], v188, s[8:11], s32 offen offset:2048 nt
    buffer_load_dwordx4 v[64:67], v188, s[8:11], s32 offen offset:3072 nt
    buffer_load_dwordx4 v[116:119], v3, s[24:27], s35 offen nt
    buffer_load_dwordx4 v[124:127], v3, s[28:31], s35 offen nt
    buffer_load_dwordx4 v[132:135], v1, s[12:15], s33 offen offset:0 nt
    buffer_load_dwordx4 v[136:139], v1, s[12:15], s33 offen offset:1024 nt
    buffer_load_dwordx4 v[140:143], v1, s[12:15], s33 offen offset:2048 nt
    buffer_load_dwordx4 v[144:147], v1, s[12:15], s33 offen offset:3072 nt
    buffer_load_dwordx4 v[148:151], v188, s[12:15], s33 offen offset:0 nt
    buffer_load_dwordx4 v[152:155], v188, s[12:15], s33 offen offset:1024 nt
    buffer_load_dwordx4 v[156:159], v188, s[12:15], s33 offen offset:2048 nt
    buffer_load_dwordx4 v[160:163], v188, s[12:15], s33 offen offset:3072 nt
    v_mov_b32 v7, s87
    s_waitcnt lgkmcnt(0)
    ds_write_b32 v6, v7
    v_add_u32 v4, s39, v4
    v_add_u32 v5, s39, v5
    v_add_u32 v6, s39, v6
    s_sub_u32 s39, 0, s39
    s_waitcnt lgkmcnt(0)
    s_barrier
L_ploop:
    s_mov_b32 s6, s87
    s_cmp_lt_u32 s6, 0x100
    s_cbranch_scc1 L_plast1
    s_add_u32 s84, s84, 1
    s_waitcnt vmcnt(10)
    s_cmp_lt_u32 s84, 7
    s_cbranch_scc1 L_st_1
    s_mov_b32 s87, 0xffff
    s_cmp_lg_u32 s3, 0
    s_cbranch_scc1 L_go_2
    s_cmp_lg_u32 s85, 0
    s_cbranch_scc1 L_go_2
    s_mov_b32 s80, s82
    s_atomic_add s80, s[76:77], 0 glc
    s_branch L_go_2
L_st_1:
    s_add_u32 s87, s87, 16
    s_cmp_lg_u32 s3, 0
    s_cbranch_scc1 L_go_2
    s_lshl_b32 s81, s84, 16
    s_or_b32 s81, s81, s87
    v_mov_b32 v7, s81
    ds_write_b32 v6, v7
L_go_2:
    v_lshlrev_b32 v8, 16, v32
    v_and_b32 v9, 0xffff0000, v32
    v_lshlrev_b32 v10, 16, v33
    v_and_b32 v11, 0xffff0000, v33
    v_lshlrev_b32 v16, 16, v34
    v_and_b32 v17, 0xffff0000, v34
    v_lshlrev_b32 v18, 16, v35
    v_and_b32 v19, 0xffff0000, v35
    v_mul_f32 v8, s36, v8
    v_mul_f32 v9, s36, v9
    v_mul_f32 v10, s36, v10
    v_mul_f32 v11, s36, v11
    v_mul_f32_e64 v16, -v16, v8
    v_mul_f32_e64 v17, -v17, v9
    v_mul_f32_e64 v18, -v18, v10
    v_mul_f32_e64 v19, -v19, v11
    v_cvt_f32_i32 v36, v36
    v_cvt_f32_i32 v37, v37
    v_cvt_f32_i32 v38, v38
    v_cvt_f32_i32 v39, v39
    v_fma_f32 v36, v36, v8, v16
    v_fma_f32 v37, v37, v9, v17
    v_fma_f32 v38, v38, v10, v18
    v_fma_f32 v39, v39, v11, v19
    v_cvt_pk_bf16_f32 v24, v36, v37
    v_cvt_pk_bf16_f32 v25, v38, v39
    ds_write_b64 v4, v[24:25] offset:0
    v_cvt_f32_i32 v40, v40
    v_cvt_f32_i32 v41, v41
    v_cvt_f32_i32 v42, v42
    v_cvt_f32_i32 v43, v43
    v_fma_f32 v40, v40, v8, v16
    v_fma_f32 v41, v41, v9, v17
    v_fma_f32 v42, v42, v10, v18
    v_fma_f32 v43, v43, v11, v19
    v_cvt_pk_bf16_f32 v26, v40, v41
    v_cvt_pk_bf16_f32 v27, v42, v43
    ds_write_b64 v4, v[26:27] offset:272
    v_cvt_f32_i32 v44, v44
    v_cvt_f32_i32 v45, v45
    v_cvt_f32_i32 v46, v46
    v_cvt_f32_i32 v47, v47
    v_fma_f32 v44, v44, v8, v16
    v_fma_f32 v45, v45, v9, v17
    v_fma_f32 v46, v46, v10, v18
    v_fma_f32 v47, v47, v11, v19
    v_cvt_pk_bf16_f32 v28, v44, v45
    v_cvt_pk_bf16_f32 v29, v46, v47
    ds_write_b64 v4, v[28:29] offset:544
    v_cvt_f32_i32 v48, v48
    v_cvt_f32_i32 v49, v49
    v_cvt_f32_i32 v50, v50
    v_cvt_f32_i32 v51, v51
    v_fma_f32 v48, v48, v8, v16
    v_fma_f32 v49, v49, v9, v17
    v_fma_f32 v50, v50, v10, v18
    v_fma_f32 v51, v51, v11, v19
    v_cvt_pk_bf16_f32 v30, v48, v49
    v_cvt_pk_bf16_f32 v31, v50, v51
    ds_write_b64 v4, v[30:31] offset:816
    v_cvt_f32_i32 v52, v52
    v_cvt_f32_i32 v53, v53
    v_cvt_f32_i32 v54, v54
    v_cvt_f32_i32 v55, v55
    v_fma_f32 v52, v52, v8, v16
    v_fma_f32 v53, v53, v9, v17
    v_fma_f32 v54, v54, v10, v18
    v_fma_f32 v55, v55, v11, v19
    v_cvt_pk_bf16_f32 v24, v52, v53
    v_cvt_pk_bf16_f32 v25, v54, v55
    ds_write_b64 v4, v[24:25] offset:2176
    v_cvt_f32_i32 v56, v56
    v_cvt_f32_i32 v57, v57
    v_cvt_f32_i32 v58, v58
    v_cvt_f32_i32 v59, v59
    v_fma_f32 v56, v56, v8, v16
    v_fma_f32 v57, v57, v9, v17
    v_fma_f32 v58, v58, v10, v18
    v_fma_f32 v59, v59, v11, v19
    v_cvt_pk_bf16_f32 v26, v56, v57
    v_cvt_pk_bf16_f32 v27, v58, v59
    ds_write_b64 v4, v[26:27] offset:2448
    v_cvt_f32_i32 v60, v60
    v_cvt_f32_i32 v61, v61
    v_cvt_f32_i32 v62, v62
    v_cvt_f32_i32 v63, v63
    v_fma_f32 v60, v60, v8, v16
    v_fma_f32 v61, v61, v9, v17
    v_fma_f32 v62, v62, v10, v18
    v_fma_f32 v63, v63, v11, v19
    v_cvt_pk_bf16_f32 v28, v60, v61
    v_cvt_pk_bf16_f32 v29, v62, v63
    ds_write_b64 v4, v[28:29] offset:2720
    v_cvt_f32_i32 v64, v64
    v_cvt_f32_i32 v65, v65
    v_cvt_f32_i32 v66, v66
    v_cvt_f32_i32 v67, v67
    v_fma_f32 v64, v64, v8, v16
    v_fma_f32 v65, v65, v9, v17
    v_fma_f32 v66, v66, v10, v18
    v_fma_f32 v67, v67, v11, v19
    v_cvt_pk_bf16_f32 v30, v64, v65
    v_cvt_pk_bf16_f32 v31, v66, v67
    ds_write_b64 v4, v[30:31] offset:2992
    s_cmp_lg_u32 s87, 0xffff
    s_cbranch_scc1 L_hv_4
    s_cmp_lg_u32 s3, 0
    s_cbranch_scc1 L_pl_3
    s_mov_b32 s87, 0
    s_cmp_lg_u32 s85, 0
    s_cbranch_scc1 L_tw_6
    s_waitcnt lgkmcnt(0)
    s_mov_b32 s85, 1
    s_cmp_ge_u32 s80, 128
    s_cbranch_scc1 L_tw_6
    s_mov_b32 s85, 0
    s_sub_u32 s81, 128, s80
    s_min_u32 s81, s81, s82
    s_lshl_b32 s81, s81, 8
    s_add_u32 s87, s80, 128
    s_or_b32 s87, s87, s81
    s_cmp_lt_u32 s80, 108
    s_cselect_b32 s82, 4, 2
L_tw_6:
    s_lshl_b32 s81, s84, 16
    s_or_b32 s81, s81, s87
    v_mov_b32 v7, s81
    ds_write_b32 v6, v7
    s_branch L_hv_4
L_pl_3:
    ds_read_b32 v7, v6
    s_waitcnt lgkmcnt(0)
    v_readfirstlane_b32 s80, v7
    s_lshr_b32 s81, s80, 16
    s_cmp_lg_u32 s81, s84
    s_cbranch_scc1 L_pl_3
    s_and_b32 s87, s80, 0xffff
L_hv_4:
    s_cmp_lt_u32 s87, 0x100
    s_cbranch_scc1 L_ni_5
    s_and_b32 s38, s87, 0xff
    s_add_u32 s38, s38, s3
    s_lshr_b32 s37, s87, 8
    s_cmp_lt_u32 s3, s37
    s_cselect_b32 s38, s38, 0x1ff
    s_lshl_b32 s32, s38, 13
    s_lshr_b32 s34, s38, 1
    s_lshl_b32 s34, s34, 8
    s_lshl_b32 s33, s38, 13
    s_lshl_b32 s35, s38, 5
    buffer_load_dwordx2 v[32:33], v2, s[16:19], s34 offen nt
    buffer_load_dwordx2 v[34:35], v2, s[20:23], s34 offen nt
    buffer_load_dwordx4 v[36:39], v1, s[8:11], s32 offen offset:0 nt
    buffer_load_dwordx4 v[40:43], v1, s[8:11], s32 offen offset:1024 nt
    buffer_load_dwordx4 v[44:47], v1, s[8:11], s32 offen offset:2048 nt
    buffer_load_dwordx4 v[48:51], v1, s[8:11], s32 offen offset:3072 nt
    buffer_load_dwordx4 v[52:55], v188, s[8:11], s32 offen offset:0 nt
    buffer_load_dwordx4 v[56:59], v188, s[8:11], s32 offen offset:1024 nt
    buffer_load_dwordx4 v[60:63], v188, s[8:11], s32 offen offset:2048 nt
    buffer_load_dwordx4 v[64:67], v188, s[8:11], s32 offen offset:3072 nt
L_ni_5:
    v_mov_b32 v72, v68
    v_mov_b32 v73, v69
    v_mov_b32 v74, v70
    v_mov_b32 v75, v71
    v_mov_b32 v80, v76
    v_mov_b32 v81, v77
    v_mov_b32 v82, v78
    v_mov_b32 v83, v79
    s_nop 0
    v_permlane32_swap_b32 v68, v72
    v_permlane32_swap_b32 v69, v73
    v_permlane32_swap_b32 v70, v74
    v_permlane32_swap_b32 v71, v75
    v_permlane32_swap_b32 v76, v80
    v_permlane32_swap_b32 v77, v81
    v_permlane32_swap_b32 v78, v82
    v_permlane32_swap_b32 v79, v83
    v_perm_b32 v8, v68, v68, v189
    v_perm_b32 v9, v69, v69, v189
    v_perm_b32 v10, v70, v70, v189
    v_perm_b32 v11, v71, v71, v189
    v_perm_b32 v12, v72, v72, v189
    v_perm_b32 v13, v73, v73, v189
    v_perm_b32 v14, v74, v74, v189
    v_perm_b32 v15, v75, v75, v189
    v_perm_b32 v16, v76, v76, v189
    v_perm_b32 v17, v77, v77, v189
    v_perm_b32 v18, v78, v78, v189
    v_perm_b32 v19, v79, v79, v189
    v_perm_b32 v20, v80, v80, v189
    v_perm_b32 v21, v81, v81, v189
    v_perm_b32 v22, v82, v82, v189
    v_perm_b32 v23, v83, v83, v189
    v_mul_f32_e64 v16, -v16, v8
    v_mul_f32_e64 v17, -v17, v9
    v_mul_f32_e64 v18, -v18, v10
    v_mul_f32_e64 v19, -v19, v11
    v_mul_f32_e64 v20, -v20, v12
    v_mul_f32_e64 v21, -v21, v13
    v_mul_f32_e64 v22, -v22, v14
    v_mul_f32_e64 v23, -v23, v15
    v_cvt_f32_i32 v84, v84
    v_cvt_f32_i32 v85, v85
    v_cvt_f32_i32 v86, v86
    v_cvt_f32_i32 v87, v87
    v_fma_f32 v84, v84, v8, v16
    v_fma_f32 v85, v85, v8, v16
    v_fma_f32 v86, v86, v8, v16
    v_fma_f32 v87, v87, v8, v16
    v_cvt_f32_i32 v88, v88
    v_cvt_f32_i32 v89, v89
    v_cvt_f32_i32 v90, v90
    v_cvt_f32_i32 v91, v91
    v_fma_f32 v88, v88, v9, v17
    v_fma_f32 v89, v89, v9, v17
    v_fma_f32 v90, v90, v9, v17
    v_fma_f32 v91, v91, v9, v17
    v_cvt_f32_i32 v92, v92
    v_cvt_f32_i32 v93, v93
    v_cvt_f32_i32 v94, v94
    v_cvt_f32_i32 v95, v95
    v_fma_f32 v92, v92, v10, v18
    v_fma_f32 v93, v93, v10, v18
    v_fma_f32 v94, v94, v10, v18
    v_fma_f32 v95, v95, v10, v18
    v_cvt_f32_i32 v96, v96
    v_cvt_f32_i32 v97, v97
    v_cvt_f32_i32 v98, v98
    v_cvt_f32_i32 v99, v99
    v_fma_f32 v96, v96, v11, v19
    v_fma_f32 v97, v97, v11, v19
    v_fma_f32 v98, v98, v11, v19
    v_fma_f32 v99, v99, v11, v19
    v_cvt_f32_i32 v100, v100
    v_cvt_f32_i32 v101, v101
    v_cvt_f32_i32 v102, v102
    v_cvt_f32_i32 v103, v103
    v_fma_f32 v100, v100, v12, v20
    v_fma_f32 v101, v101, v12, v20
    v_fma_f32 v102, v102, v12, v20
    v_fma_f32 v103, v103, v12, v20
    v_cvt_f32_i32 v104, v104
    v_cvt_f32_i32 v105, v105
    v_cvt_f32_i32 v106, v106
    v_cvt_f32_i32 v107, v107
    v_fma_f32 v104, v104, v13, v21
    v_fma_f32 v105, v105, v13, v21
    v_fma_f32 v106, v106, v13, v21
    v_fma_f32 v107, v107, v13, v21
    v_cvt_f32_i32 v108, v108
    v_cvt_f32_i32 v109, v109
    v_cvt_f32_i32 v110, v110
    v_cvt_f32_i32 v111, v111
    v_fma_f32 v108, v108, v14, v22
    v_fma_f32 v109, v109, v14, v22
    v_fma_f32 v110, v110, v14, v22
    v_fma_f32 v111, v111, v14, v22
    v_cvt_f32_i32 v112, v112
    v_cvt_f32_i32 v113, v113
    v_cvt_f32_i32 v114, v114
    v_cvt_f32_i32 v115, v115
    v_fma_f32 v112, v112, v15, v23
    v_fma_f32 v113, v113, v15, v23
    v_fma_f32 v114, v114, v15, v23
    v_fma_f32 v115, v115, v15, v23
    v_cvt_pk_bf16_f32 v8, v84, v88
    v_cvt_pk_bf16_f32 v9, v92, v96
    v_cvt_pk_bf16_f32 v10, v100, v104
    v_cvt_pk_bf16_f32 v11, v108, v112
    ds_write_b128 v5, v[8:11] offset:0
    v_cvt_pk_bf16_f32 v12, v85, v89
    v_cvt_pk_bf16_f32 v13, v93, v97
    v_cvt_pk_bf16_f32 v14, v101, v105
    v_cvt_pk_bf16_f32 v15, v109, v113
    ds_write_b128 v5, v[12:15] offset:1024
    v_cvt_pk_bf16_f32 v16, v86, v90
    v_cvt_pk_bf16_f32 v17, v94, v98
    v_cvt_pk_bf16_f32 v18, v102, v106
    v_cvt_pk_bf16_f32 v19, v110, v114
    ds_write_b128 v5, v[16:19] offset:2048
    v_cvt_pk_bf16_f32 v20, v87, v91
    v_cvt_pk_bf16_f32 v21, v95, v99
    v_cvt_pk_bf16_f32 v22, v103, v107
    v_cvt_pk_bf16_f32 v23, v111, v115
    ds_write_b128 v5, v[20:23] offset:3072
    s_cmp_lt_u32 s87, 0x100
    s_cbranch_scc1 L_n2_7
    buffer_load_dwordx4 v[68:71], v3, s[24:27], s35 offen nt
    buffer_load_dwordx4 v[76:79], v3, s[28:31], s35 offen nt
    buffer_load_dwordx4 v[84:87], v1, s[12:15], s33 offen offset:0 nt
    buffer_load_dwordx4 v[88:91], v1, s[12:15], s33 offen offset:1024 nt
    buffer_load_dwordx4 v[92:95], v1, s[12:15], s33 offen offset:2048 nt
    buffer_load_dwordx4 v[96:99], v1, s[12:15], s33 offen offset:3072 nt
    buffer_load_dwordx4 v[100:103], v188, s[12:15], s33 offen offset:0 nt
    buffer_load_dwordx4 v[104:107], v188, s[12:15], s33 offen offset:1024 nt
    buffer_load_dwordx4 v[108:111], v188, s[12:15], s33 offen offset:2048 nt
    buffer_load_dwordx4 v[112:115], v188, s[12:15], s33 offen offset:3072 nt
L_n2_7:
    v_add_u32 v4, s39, v4
    v_add_u32 v5, s39, v5
    v_add_u32 v6, s39, v6
    s_sub_u32 s39, 0, s39
    s_waitcnt lgkmcnt(0)
    s_barrier
    s_mov_b32 s6, s87
    s_cmp_lt_u32 s6, 0x100
    s_cbranch_scc1 L_plast0
    s_add_u32 s84, s84, 1
    s_waitcnt vmcnt(10)
    s_cmp_lt_u32 s84, 7
    s_cbranch_scc1 L_st_8
    s_mov_b32 s87, 0xffff
    s_cmp_lg_u32 s3, 0
    s_cbranch_scc1 L_go_9
    s_cmp_lg_u32 s85, 0
    s_cbranch_scc1 L_go_9
    s_mov_b32 s80, s82
    s_atomic_add s80, s[76:77], 0 glc
    s_branch L_go_9
L_st_8:
    s_add_u32 s87, s87, 16
    s_cmp_lg_u32 s3, 0
    s_cbranch_scc1 L_go_9
    s_lshl_b32 s81, s84, 16
    s_or_b32 s81, s81, s87
    v_mov_b32 v7, s81
    ds_write_b32 v6, v7
L_go_9:
    v_lshlrev_b32 v8, 16, v32
    v_and_b32 v9, 0xffff0000, v32
    v_lshlrev_b32 v10, 16, v33
    v_and_b32 v11, 0xffff0000, v33
    v_lshlrev_b32 v16, 16, v34
    v_and_b32 v17, 0xffff0000, v34
    v_lshlrev_b32 v18, 16, v35
    v_and_b32 v19, 0xffff0000, v35
    v_mul_f32 v8, s36, v8
    v_mul_f32 v9, s36, v9
    v_mul_f32 v10, s36, v10
    v_mul_f32 v11, s36, v11
    v_mul_f32_e64 v16, -v16, v8
    v_mul_f32_e64 v17, -v17, v9
    v_mul_f32_e64 v18, -v18, v10
    v_mul_f32_e64 v19, -v19, v11
    v_cvt_f32_i32 v36, v36
    v_cvt_f32_i32 v37, v37
    v_cvt_f32_i32 v38, v38
    v_cvt_f32_i32 v39, v39
    v_fma_f32 v36, v36, v8, v16
    v_fma_f32 v37, v37, v9, v17
    v_fma_f32 v38, v38, v10, v18
    v_fma_f32 v39, v39, v11, v19
    v_cvt_pk_bf16_f32 v24, v36, v37
    v_cvt_pk_bf16_f32 v25, v38, v39
    ds_write_b64 v4, v[24:25] offset:0
    v_cvt_f32_i32 v40, v40
    v_cvt_f32_i32 v41, v41
    v_cvt_f32_i32 v42, v42
    v_cvt_f32_i32 v43, v43
    v_fma_f32 v40, v40, v8, v16
    v_fma_f32 v41, v41, v9, v17
    v_fma_f32 v42, v42, v10, v18
    v_fma_f32 v43, v43, v11, v19
    v_cvt_pk_bf16_f32 v26, v40, v41
    v_cvt_pk_bf16_f32 v27, v42, v43
    ds_write_b64 v4, v[26:27] offset:272
    v_cvt_f32_i32 v44, v44
    v_cvt_f32_i32 v45, v45
    v_cvt_f32_i32 v46, v46
    v_cvt_f32_i32 v47, v47
    v_fma_f32 v44, v44, v8, v16
    v_fma_f32 v45, v45, v9, v17
    v_fma_f32 v46, v46, v10, v18
    v_fma_f32 v47, v47, v11, v19
    v_cvt_pk_bf16_f32 v28, v44, v45
    v_cvt_pk_bf16_f32 v29, v46, v47
    ds_write_b64 v4, v[28:29] offset:544
    v_cvt_f32_i32 v48, v48
    v_cvt_f32_i32 v49, v49
    v_cvt_f32_i32 v50, v50
    v_cvt_f32_i32 v51, v51
    v_fma_f32 v48, v48, v8, v16
    v_fma_f32 v49, v49, v9, v17
    v_fma_f32 v50, v50, v10, v18
    v_fma_f32 v51, v51, v11, v19
    v_cvt_pk_bf16_f32 v30, v48, v49
    v_cvt_pk_bf16_f32 v31, v50, v51
    ds_write_b64 v4, v[30:31] offset:816
    v_cvt_f32_i32 v52, v52
    v_cvt_f32_i32 v53, v53
    v_cvt_f32_i32 v54, v54
    v_cvt_f32_i32 v55, v55
    v_fma_f32 v52, v52, v8, v16
    v_fma_f32 v53, v53, v9, v17
    v_fma_f32 v54, v54, v10, v18
    v_fma_f32 v55, v55, v11, v19
    v_cvt_pk_bf16_f32 v24, v52, v53
    v_cvt_pk_bf16_f32 v25, v54, v55
    ds_write_b64 v4, v[24:25] offset:2176
    v_cvt_f32_i32 v56, v56
    v_cvt_f32_i32 v57, v57
    v_cvt_f32_i32 v58, v58
    v_cvt_f32_i32 v59, v59
    v_fma_f32 v56, v56, v8, v16
    v_fma_f32 v57, v57, v9, v17
    v_fma_f32 v58, v58, v10, v18
    v_fma_f32 v59, v59, v11, v19
    v_cvt_pk_bf16_f32 v26, v56, v57
    v_cvt_pk_bf16_f32 v27, v58, v59
    ds_write_b64 v4, v[26:27] offset:2448
    v_cvt_f32_i32 v60, v60
    v_cvt_f32_i32 v61, v61
    v_cvt_f32_i32 v62, v62
    v_cvt_f32_i32 v63, v63
    v_fma_f32 v60, v60, v8, v16
    v_fma_f32 v61, v61, v9, v17
    v_fma_f32 v62, v62, v10, v18
    v_fma_f32 v63, v63, v11, v19
    v_cvt_pk_bf16_f32 v28, v60, v61
    v_cvt_pk_bf16_f32 v29, v62, v63
    ds_write_b64 v4, v[28:29] offset:2720
    v_cvt_f32_i32 v64, v64
    v_cvt_f32_i32 v65, v65
    v_cvt_f32_i32 v66, v66
    v_cvt_f32_i32 v67, v67
    v_fma_f32 v64, v64, v8, v16
    v_fma_f32 v65, v65, v9, v17
    v_fma_f32 v66, v66, v10, v18
    v_fma_f32 v67, v67, v11, v19
    v_cvt_pk_bf16_f32 v30, v64, v65
    v_cvt_pk_bf16_f32 v31, v66, v67
    ds_write_b64 v4, v[30:31] offset:2992
    s_cmp_lg_u32 s87, 0xffff
    s_cbranch_scc1 L_hv_11
    s_cmp_lg_u32 s3, 0
    s_cbranch_scc1 L_pl_10
    s_mov_b32 s87, 0
    s_cmp_lg_u32 s85, 0
    s_cbranch_scc1 L_tw_13
    s_waitcnt lgkmcnt(0)
    s_mov_b32 s85, 1
    s_cmp_ge_u32 s80, 128
    s_cbranch_scc1 L_tw_13
    s_mov_b32 s85, 0
    s_sub_u32 s81, 128, s80
    s_min_u32 s81, s81, s82
    s_lshl_b32 s81, s81, 8
    s_add_u32 s87, s80, 128
    s_or_b32 s87, s87, s81
    s_cmp_lt_u32 s80, 108
    s_cselect_b32 s82, 4, 2
L_tw_13:
    s_lshl_b32 s81, s84, 16
    s_or_b32 s81, s81, s87
    v_mov_b32 v7, s81
    ds_write_b32 v6, v7
    s_branch L_hv_11
L_pl_10:
    ds_read_b32 v7, v6
    s_waitcnt lgkmcnt(0)
    v_readfirstlane_b32 s80, v7
    s_lshr_b32 s81, s80, 16
    s_cmp_lg_u32 s81, s84
    s_cbranch_scc1 L_pl_10
    s_and_b32 s87, s80, 0xffff
L_hv_11:
    s_cmp_lt_u32 s87, 0x100
    s_cbranch_scc1 L_ni_12
    s_and_b32 s38, s87, 0xff
    s_add_u32 s38, s38, s3
    s_lshr_b32 s37, s87, 8
    s_cmp_lt_u32 s3, s37
    s_cselect_b32 s38, s38, 0x1ff
    s_lshl_b32 s32, s38, 13
    s_lshr_b32 s34, s38, 1
    s_lshl_b32 s34, s34, 8
    s_lshl_b32 s33, s38, 13
    s_lshl_b32 s35, s38, 5
    buffer_load_dwordx2 v[32:33], v2, s[16:19], s34 offen nt
    buffer_load_dwordx2 v[34:35], v2, s[20:23], s34 offen nt
    buffer_load_dwordx4 v[36:39], v1, s[8:11], s32 offen offset:0 nt
    buffer_load_dwordx4 v[40:43], v1, s[8:11], s32 offen offset:1024 nt
    buffer_load_dwordx4 v[44:47], v1, s[8:11], s32 offen offset:2048 nt
    buffer_load_dwordx4 v[48:51], v1, s[8:11], s32 offen offset:3072 nt
    buffer_load_dwordx4 v[52:55], v188, s[8:11], s32 offen offset:0 nt
    buffer_load_dwordx4 v[56:59], v188, s[8:11], s32 offen offset:1024 nt
    buffer_load_dwordx4 v[60:63], v188, s[8:11], s32 offen offset:2048 nt
    buffer_load_dwordx4 v[64:67], v188, s[8:11], s32 offen offset:3072 nt
L_ni_12:
    v_mov_b32 v120, v116
    v_mov_b32 v121, v117
    v_mov_b32 v122, v118
    v_mov_b32 v123, v119
    v_mov_b32 v128, v124
    v_mov_b32 v129, v125
    v_mov_b32 v130, v126
    v_mov_b32 v131, v127
    s_nop 0
    v_permlane32_swap_b32 v116, v120
    v_permlane32_swap_b32 v117, v121
    v_permlane32_swap_b32 v118, v122
    v_permlane32_swap_b32 v119, v123
    v_permlane32_swap_b32 v124, v128
    v_permlane32_swap_b32 v125, v129
    v_permlane32_swap_b32 v126, v130
    v_permlane32_swap_b32 v127, v131
    v_perm_b32 v8, v116, v116, v189
    v_perm_b32 v9, v117, v117, v189
    v_perm_b32 v10, v118, v118, v189
    v_perm_b32 v11, v119, v119, v189
    v_perm_b32 v12, v120, v120, v189
    v_perm_b32 v13, v121, v121, v189
    v_perm_b32 v14, v122, v122, v189
    v_perm_b32 v15, v123, v123, v189
    v_perm_b32 v16, v124, v124, v189
    v_perm_b32 v17, v125, v125, v189
    v_perm_b32 v18, v126, v126, v189
    v_perm_b32 v19, v127, v127, v189
    v_perm_b32 v20, v128, v128, v189
    v_perm_b32 v21, v129, v129, v189
    v_perm_b32 v22, v130, v130, v189
    v_perm_b32 v23, v131, v131, v189
    v_mul_f32_e64 v16, -v16, v8
    v_mul_f32_e64 v17, -v17, v9
    v_mul_f32_e64 v18, -v18, v10
    v_mul_f32_e64 v19, -v19, v11
    v_mul_f32_e64 v20, -v20, v12
    v_mul_f32_e64 v21, -v21, v13
    v_mul_f32_e64 v22, -v22, v14
    v_mul_f32_e64 v23, -v23, v15
    v_cvt_f32_i32 v132, v132
    v_cvt_f32_i32 v133, v133
    v_cvt_f32_i32 v134, v134
    v_cvt_f32_i32 v135, v135
    v_fma_f32 v132, v132, v8, v16
    v_fma_f32 v133, v133, v8, v16
    v_fma_f32 v134, v134, v8, v16
    v_fma_f32 v135, v135, v8, v16
    v_cvt_f32_i32 v136, v136
    v_cvt_f32_i32 v137, v137
    v_cvt_f32_i32 v138, v138
    v_cvt_f32_i32 v139, v139
    v_fma_f32 v136, v136, v9, v17
    v_fma_f32 v137, v137, v9, v17
    v_fma_f32 v138, v138, v9, v17
    v_fma_f32 v139, v139, v9, v17
    v_cvt_f32_i32 v140, v140
    v_cvt_f32_i32 v141, v141
    v_cvt_f32_i32 v142, v142
    v_cvt_f32_i32 v143, v143
    v_fma_f32 v140, v140, v10, v18
    v_fma_f32 v141, v141, v10, v18
    v_fma_f32 v142, v142, v10, v18
    v_fma_f32 v143, v143, v10, v18
    v_cvt_f32_i32 v144, v144
    v_cvt_f32_i32 v145, v145
    v_cvt_f32_i32 v146, v146
    v_cvt_f32_i32 v147, v147
    v_fma_f32 v144, v144, v11, v19
    v_fma_f32 v145, v145, v11, v19
    v_fma_f32 v146, v146, v11, v19
    v_fma_f32 v147, v147, v11, v19
    v_cvt_f32_i32 v148, v148
    v_cvt_f32_i32 v149, v149
    v_cvt_f32_i32 v150, v150
    v_cvt_f32_i32 v151, v151
    v_fma_f32 v148, v148, v12, v20
    v_fma_f32 v149, v149, v12, v20
    v_fma_f32 v150, v150, v12, v20
    v_fma_f32 v151, v151, v12, v20
    v_cvt_f32_i32 v152, v152
    v_cvt_f32_i32 v153, v153
    v_cvt_f32_i32 v154, v154
    v_cvt_f32_i32 v155, v155
    v_fma_f32 v152, v152, v13, v21
    v_fma_f32 v153, v153, v13, v21
    v_fma_f32 v154, v154, v13, v21
    v_fma_f32 v155, v155, v13, v21
    v_cvt_f32_i32 v156, v156
    v_cvt_f32_i32 v157, v157
    v_cvt_f32_i32 v158, v158
    v_cvt_f32_i32 v159, v159
    v_fma_f32 v156, v156, v14, v22
    v_fma_f32 v157, v157, v14, v22
    v_fma_f32 v158, v158, v14, v22
    v_fma_f32 v159, v159, v14, v22
    v_cvt_f32_i32 v160, v160
    v_cvt_f32_i32 v161, v161
    v_cvt_f32_i32 v162, v162
    v_cvt_f32_i32 v163, v163
    v_fma_f32 v160, v160, v15, v23
    v_fma_f32 v161, v161, v15, v23
    v_fma_f32 v162, v162, v15, v23
    v_fma_f32 v163, v163, v15, v23
    v_cvt_pk_bf16_f32 v8, v132, v136
    v_cvt_pk_bf16_f32 v9, v140, v144
    v_cvt_pk_bf16_f32 v10, v148, v152
    v_cvt_pk_bf16_f32 v11, v156, v160
    ds_write_b128 v5, v[8:11] offset:0
    v_cvt_pk_bf16_f32 v12, v133, v137
    v_cvt_pk_bf16_f32 v13, v141, v145
    v_cvt_pk_bf16_f32 v14, v149, v153
    v_cvt_pk_bf16_f32 v15, v157, v161
    ds_write_b128 v5, v[12:15] offset:1024
    v_cvt_pk_bf16_f32 v16, v134, v138
    v_cvt_pk_bf16_f32 v17, v142, v146
    v_cvt_pk_bf16_f32 v18, v150, v154
    v_cvt_pk_bf16_f32 v19, v158, v162
    ds_write_b128 v5, v[16:19] offset:2048
    v_cvt_pk_bf16_f32 v20, v135, v139
    v_cvt_pk_bf16_f32 v21, v143, v147
    v_cvt_pk_bf16_f32 v22, v151, v155
    v_cvt_pk_bf16_f32 v23, v159, v163
    ds_write_b128 v5, v[20:23] offset:3072
    s_cmp_lt_u32 s87, 0x100
    s_cbranch_scc1 L_n2_14
    buffer_load_dwordx4 v[116:119], v3, s[24:27], s35 offen nt
    buffer_load_dwordx4 v[124:127], v3, s[28:31], s35 offen nt
    buffer_load_dwordx4 v[132:135], v1, s[12:15], s33 offen offset:0 nt
    buffer_load_dwordx4 v[136:139], v1, s[12:15], s33 offen offset:1024 nt
    buffer_load_dwordx4 v[140:143], v1, s[12:15], s33 offen offset:2048 nt
    buffer_load_dwordx4 v[144:147], v1, s[12:15], s33 offen offset:3072 nt
    buffer_load_dwordx4 v[148:151], v188, s[12:15], s33 offen offset:0 nt
    buffer_load_dwordx4 v[152:155], v188, s[12:15], s33 offen offset:1024 nt
    buffer_load_dwordx4 v[156:159], v188, s[12:15], s33 offen offset:2048 nt
    buffer_load_dwordx4 v[160:163], v188, s[12:15], s33 offen offset:3072 nt
L_n2_14:
    v_add_u32 v4, s39, v4
    v_add_u32 v5, s39, v5
    v_add_u32 v6, s39, v6
    s_sub_u32 s39, 0, s39
    s_waitcnt lgkmcnt(0)
    s_barrier
    s_branch L_ploop
L_plast1:
    s_waitcnt vmcnt(0)
    v_mov_b32 v72, v68
    v_mov_b32 v73, v69
    v_mov_b32 v74, v70
    v_mov_b32 v75, v71
    v_mov_b32 v80, v76
    v_mov_b32 v81, v77
    v_mov_b32 v82, v78
    v_mov_b32 v83, v79
    s_nop 0
    v_permlane32_swap_b32 v68, v72
    v_permlane32_swap_b32 v69, v73
    v_permlane32_swap_b32 v70, v74
    v_permlane32_swap_b32 v71, v75
    v_permlane32_swap_b32 v76, v80
    v_permlane32_swap_b32 v77, v81
    v_permlane32_swap_b32 v78, v82
    v_permlane32_swap_b32 v79, v83
    v_perm_b32 v8, v68, v68, v189
    v_perm_b32 v9, v69, v69, v189
    v_perm_b32 v10, v70, v70, v189
    v_perm_b32 v11, v71, v71, v189
    v_perm_b32 v12, v72, v72, v189
    v_perm_b32 v13, v73, v73, v189
    v_perm_b32 v14, v74, v74, v189
    v_perm_b32 v15, v75, v75, v189
    v_perm_b32 v16, v76, v76, v189
    v_perm_b32 v17, v77, v77, v189
    v_perm_b32 v18, v78, v78, v189
    v_perm_b32 v19, v79, v79, v189
    v_perm_b32 v20, v80, v80, v189
    v_perm_b32 v21, v81, v81, v189
    v_perm_b32 v22, v82, v82, v189
    v_perm_b32 v23, v83, v83, v189
    v_mul_f32_e64 v16, -v16, v8
    v_mul_f32_e64 v17, -v17, v9
    v_mul_f32_e64 v18, -v18, v10
    v_mul_f32_e64 v19, -v19, v11
    v_mul_f32_e64 v20, -v20, v12
    v_mul_f32_e64 v21, -v21, v13
    v_mul_f32_e64 v22, -v22, v14
    v_mul_f32_e64 v23, -v23, v15
    v_cvt_f32_i32 v84, v84
    v_cvt_f32_i32 v85, v85
    v_cvt_f32_i32 v86, v86
    v_cvt_f32_i32 v87, v87
    v_fma_f32 v84, v84, v8, v16
    v_fma_f32 v85, v85, v8, v16
    v_fma_f32 v86, v86, v8, v16
    v_fma_f32 v87, v87, v8, v16
    v_cvt_f32_i32 v88, v88
    v_cvt_f32_i32 v89, v89
    v_cvt_f32_i32 v90, v90
    v_cvt_f32_i32 v91, v91
    v_fma_f32 v88, v88, v9, v17
    v_fma_f32 v89, v89, v9, v17
    v_fma_f32 v90, v90, v9, v17
    v_fma_f32 v91, v91, v9, v17
    v_cvt_f32_i32 v92, v92
    v_cvt_f32_i32 v93, v93
    v_cvt_f32_i32 v94, v94
    v_cvt_f32_i32 v95, v95
    v_fma_f32 v92, v92, v10, v18
    v_fma_f32 v93, v93, v10, v18
    v_fma_f32 v94, v94, v10, v18
    v_fma_f32 v95, v95, v10, v18
    v_cvt_f32_i32 v96, v96
    v_cvt_f32_i32 v97, v97
    v_cvt_f32_i32 v98, v98
    v_cvt_f32_i32 v99, v99
    v_fma_f32 v96, v96, v11, v19
    v_fma_f32 v97, v97, v11, v19
    v_fma_f32 v98, v98, v11, v19
    v_fma_f32 v99, v99, v11, v19
    v_cvt_f32_i32 v100, v100
    v_cvt_f32_i32 v101, v101
    v_cvt_f32_i32 v102, v102
    v_cvt_f32_i32 v103, v103
    v_fma_f32 v100, v100, v12, v20
    v_fma_f32 v101, v101, v12, v20
    v_fma_f32 v102, v102, v12, v20
    v_fma_f32 v103, v103, v12, v20
    v_cvt_f32_i32 v104, v104
    v_cvt_f32_i32 v105, v105
    v_cvt_f32_i32 v106, v106
    v_cvt_f32_i32 v107, v107
    v_fma_f32 v104, v104, v13, v21
    v_fma_f32 v105, v105, v13, v21
    v_fma_f32 v106, v106, v13, v21
    v_fma_f32 v107, v107, v13, v21
    v_cvt_f32_i32 v108, v108
    v_cvt_f32_i32 v109, v109
    v_cvt_f32_i32 v110, v110
    v_cvt_f32_i32 v111, v111
    v_fma_f32 v108, v108, v14, v22
    v_fma_f32 v109, v109, v14, v22
    v_fma_f32 v110, v110, v14, v22
    v_fma_f32 v111, v111, v14, v22
    v_cvt_f32_i32 v112, v112
    v_cvt_f32_i32 v113, v113
    v_cvt_f32_i32 v114, v114
    v_cvt_f32_i32 v115, v115
    v_fma_f32 v112, v112, v15, v23
    v_fma_f32 v113, v113, v15, v23
    v_fma_f32 v114, v114, v15, v23
    v_fma_f32 v115, v115, v15, v23
    v_cvt_pk_bf16_f32 v8, v84, v88
    v_cvt_pk_bf16_f32 v9, v92, v96
    v_cvt_pk_bf16_f32 v10, v100, v104
    v_cvt_pk_bf16_f32 v11, v108, v112
    ds_write_b128 v5, v[8:11] offset:0
    v_cvt_pk_bf16_f32 v12, v85, v89
    v_cvt_pk_bf16_f32 v13, v93, v97
    v_cvt_pk_bf16_f32 v14, v101, v105
    v_cvt_pk_bf16_f32 v15, v109, v113
    ds_write_b128 v5, v[12:15] offset:1024
    v_cvt_pk_bf16_f32 v16, v86, v90
    v_cvt_pk_bf16_f32 v17, v94, v98
    v_cvt_pk_bf16_f32 v18, v102, v106
    v_cvt_pk_bf16_f32 v19, v110, v114
    ds_write_b128 v5, v[16:19] offset:2048
    v_cvt_pk_bf16_f32 v20, v87, v91
    v_cvt_pk_bf16_f32 v21, v95, v99
    v_cvt_pk_bf16_f32 v22, v103, v107
    v_cvt_pk_bf16_f32 v23, v111, v115
    ds_write_b128 v5, v[20:23] offset:3072
    s_branch L_ptail
L_plast0:
    s_waitcnt vmcnt(0)
    v_mov_b32 v120, v116
    v_mov_b32 v121, v117
    v_mov_b32 v122, v118
    v_mov_b32 v123, v119
    v_mov_b32 v128, v124
    v_mov_b32 v129, v125
    v_mov_b32 v130, v126
    v_mov_b32 v131, v127
    s_nop 0
    v_permlane32_swap_b32 v116, v120
    v_permlane32_swap_b32 v117, v121
    v_permlane32_swap_b32 v118, v122
    v_permlane32_swap_b32 v119, v123
    v_permlane32_swap_b32 v124, v128
    v_permlane32_swap_b32 v125, v129
    v_permlane32_swap_b32 v126, v130
    v_permlane32_swap_b32 v127, v131
    v_perm_b32 v8, v116, v116, v189
    v_perm_b32 v9, v117, v117, v189
    v_perm_b32 v10, v118, v118, v189
    v_perm_b32 v11, v119, v119, v189
    v_perm_b32 v12, v120, v120, v189
    v_perm_b32 v13, v121, v121, v189
    v_perm_b32 v14, v122, v122, v189
    v_perm_b32 v15, v123, v123, v189
    v_perm_b32 v16, v124, v124, v189
    v_perm_b32 v17, v125, v125, v189
    v_perm_b32 v18, v126, v126, v189
    v_perm_b32 v19, v127, v127, v189
    v_perm_b32 v20, v128, v128, v189
    v_perm_b32 v21, v129, v129, v189
    v_perm_b32 v22, v130, v130, v189
    v_perm_b32 v23, v131, v131, v189
    v_mul_f32_e64 v16, -v16, v8
    v_mul_f32_e64 v17, -v17, v9
    v_mul_f32_e64 v18, -v18, v10
    v_mul_f32_e64 v19, -v19, v11
    v_mul_f32_e64 v20, -v20, v12
    v_mul_f32_e64 v21, -v21, v13
    v_mul_f32_e64 v22, -v22, v14
    v_mul_f32_e64 v23, -v23, v15
    v_cvt_f32_i32 v132, v132
    v_cvt_f32_i32 v133, v133
    v_cvt_f32_i32 v134, v134
    v_cvt_f32_i32 v135, v135
    v_fma_f32 v132, v132, v8, v16
    v_fma_f32 v133, v133, v8, v16
    v_fma_f32 v134, v134, v8, v16
    v_fma_f32 v135, v135, v8, v16
    v_cvt_f32_i32 v136, v136
    v_cvt_f32_i32 v137, v137
    v_cvt_f32_i32 v138, v138
    v_cvt_f32_i32 v139, v139
    v_fma_f32 v136, v136, v9, v17
    v_fma_f32 v137, v137, v9, v17
    v_fma_f32 v138, v138, v9, v17
    v_fma_f32 v139, v139, v9, v17
    v_cvt_f32_i32 v140, v140
    v_cvt_f32_i32 v141, v141
    v_cvt_f32_i32 v142, v142
    v_cvt_f32_i32 v143, v143
    v_fma_f32 v140, v140, v10, v18
    v_fma_f32 v141, v141, v10, v18
    v_fma_f32 v142, v142, v10, v18
    v_fma_f32 v143, v143, v10, v18
    v_cvt_f32_i32 v144, v144
    v_cvt_f32_i32 v145, v145
    v_cvt_f32_i32 v146, v146
    v_cvt_f32_i32 v147, v147
    v_fma_f32 v144, v144, v11, v19
    v_fma_f32 v145, v145, v11, v19
    v_fma_f32 v146, v146, v11, v19
    v_fma_f32 v147, v147, v11, v19
    v_cvt_f32_i32 v148, v148
    v_cvt_f32_i32 v149, v149
    v_cvt_f32_i32 v150, v150
    v_cvt_f32_i32 v151, v151
    v_fma_f32 v148, v148, v12, v20
    v_fma_f32 v149, v149, v12, v20
    v_fma_f32 v150, v150, v12, v20
    v_fma_f32 v151, v151, v12, v20
    v_cvt_f32_i32 v152, v152
    v_cvt_f32_i32 v153, v153
    v_cvt_f32_i32 v154, v154
    v_cvt_f32_i32 v155, v155
    v_fma_f32 v152, v152, v13, v21
    v_fma_f32 v153, v153, v13, v21
    v_fma_f32 v154, v154, v13, v21
    v_fma_f32 v155, v155, v13, v21
    v_cvt_f32_i32 v156, v156
    v_cvt_f32_i32 v157, v157
    v_cvt_f32_i32 v158, v158
    v_cvt_f32_i32 v159, v159
    v_fma_f32 v156, v156, v14, v22
    v_fma_f32 v157, v157, v14, v22
    v_fma_f32 v158, v158, v14, v22
    v_fma_f32 v159, v159, v14, v22
    v_cvt_f32_i32 v160, v160
    v_cvt_f32_i32 v161, v161
    v_cvt_f32_i32 v162, v162
    v_cvt_f32_i32 v163, v163
    v_fma_f32 v160, v160, v15, v23
    v_fma_f32 v161, v161, v15, v23
    v_fma_f32 v162, v162, v15, v23
    v_fma_f32 v163, v163, v15, v23
    v_cvt_pk_bf16_f32 v8, v132, v136
    v_cvt_pk_bf16_f32 v9, v140, v144
    v_cvt_pk_bf16_f32 v10, v148, v152
    v_cvt_pk_bf16_f32 v11, v156, v160
    ds_write_b128 v5, v[8:11] offset:0
    v_cvt_pk_bf16_f32 v12, v133, v137
    v_cvt_pk_bf16_f32 v13, v141, v145
    v_cvt_pk_bf16_f32 v14, v149, v153
    v_cvt_pk_bf16_f32 v15, v157, v161
    ds_write_b128 v5, v[12:15] offset:1024
    v_cvt_pk_bf16_f32 v16, v134, v138
    v_cvt_pk_bf16_f32 v17, v142, v146
    v_cvt_pk_bf16_f32 v18, v150, v154
    v_cvt_pk_bf16_f32 v19, v158, v162
    ds_write_b128 v5, v[16:19] offset:2048
    v_cvt_pk_bf16_f32 v20, v135, v139
    v_cvt_pk_bf16_f32 v21, v143, v147
    v_cvt_pk_bf16_f32 v22, v151, v155
    v_cvt_pk_bf16_f32 v23, v159, v163
    ds_write_b128 v5, v[20:23] offset:3072
L_ptail:
    s_waitcnt lgkmcnt(0)
    s_barrier
    s_endpgm
L_consumer:
    v_and_b32 v6, 31, v0
    v_bfe_u32 v7, v0, 5, 1
    v_lshlrev_b32 v8, 8, v6
    v_lshl_add_u32 v8, v7, 4, v8
    s_lshl_b32 s23, s3, 13
    s_lshl_b32 s22, s4, 15
    s_mov_b32 s10, 0x8000
    s_mov_b32 s11, 0x20000
    s_waitcnt lgkmcnt(0)
    s_add_u32 s8, s40, s22
    s_addc_u32 s9, s41, 0
    buffer_load_dwordx4 v[128:131], v8, s[8:11], s23 offen offset:0
    buffer_load_dwordx4 v[132:135], v8, s[8:11], s23 offen offset:32
    buffer_load_dwordx4 v[136:139], v8, s[8:11], s23 offen offset:64
    buffer_load_dwordx4 v[140:143], v8, s[8:11], s23 offen offset:96
    buffer_load_dwordx4 v[144:147], v8, s[8:11], s23 offen offset:128
    buffer_load_dwordx4 v[148:151], v8, s[8:11], s23 offen offset:160
    buffer_load_dwordx4 v[152:155], v8, s[8:11], s23 offen offset:192
    buffer_load_dwordx4 v[156:159], v8, s[8:11], s23 offen offset:224
    s_lshl_b32 s76, s4, 2
    s_add_u32 s76, s56, s76
    s_addc_u32 s77, s57, 0
    s_mov_b32 s20, 0x3e0293ee
    v_mul_u32_u24 v1, 272, v6
    v_lshl_add_u32 v1, v7, 4, v1
    v_and_b32 v2, 63, v0
    v_lshlrev_b32 v2, 4, v2
    v_mov_b32 v9, v2
    v_lshrrev_b32 v15, 1, v9
    v_lshlrev_b32 v28, 8, v6
    v_lshl_add_u32 v28, v7, 5, v28
    v_mov_b32 v12, v28
    v_mov_b32 v10, 33792
    v_mov_b32 v3, 0xf149f2ca
    v_mov_b32 v13, 0x45800000
    s_mov_b32 s26, 0
    v_mov_b32 v32, 0
    v_mov_b32 v33, 0
    v_mov_b32 v34, 0
    v_mov_b32 v35, 0
    v_mov_b32 v36, 0
    v_mov_b32 v37, 0
    v_mov_b32 v38, 0
    v_mov_b32 v39, 0
    v_mov_b32 v40, 0
    v_mov_b32 v41, 0
    v_mov_b32 v42, 0
    v_mov_b32 v43, 0
    v_mov_b32 v44, 0
    v_mov_b32 v45, 0
    v_mov_b32 v46, 0
    v_mov_b32 v47, 0
    v_mov_b32 v4, 0
    s_lshl_b32 s21, s4, 17
    s_add_u32 s12, s58, s21
    s_addc_u32 s13, s59, 0
    s_mov_b32 s14, 0x20000
    s_mov_b32 s15, 0x20000
    s_lshl_b32 s21, s4, 13
    s_add_u32 s21, s21, 0x800000
    s_add_u32 s16, s58, s21
    s_addc_u32 s17, s59, 0
    s_mov_b32 s18, 0x2000
    s_mov_b32 s19, 0x20000
    s_lshl_b32 s21, s4, 10
    s_add_u32 s21, s21, 0x900000
    s_add_u32 s64, s58, s21
    s_addc_u32 s65, s59, 0
    s_mov_b32 s66, 0x400
    s_mov_b32 s67, 0x20000
    s_lshl_b32 s21, s3, 7
    s_add_u32 s21, s21, 128
    s_add_u32 s78, s64, s21
    s_addc_u32 s79, s65, 0
    s_lshl_b32 s21, s5, 15
    s_add_u32 s21, s21, s23
    s_lshl_b32 s24, s3, 9
    s_lshl_b32 s25, s5, 11
    s_add_u32 s25, s25, s24
    s_lshl_b32 s82, s5, 11
    s_add_u32 s82, s82, s23
    s_add_u32 s68, s5, 1
    s_and_b32 s68, s68, 3
    s_lshl_b32 s70, s68, 15
    s_add_u32 s70, s70, s82
    s_lshl_b32 s73, s68, 11
    s_add_u32 s73, s73, s24
    s_add_u32 s68, s5, 2
    s_and_b32 s68, s68, 3
    s_lshl_b32 s71, s68, 15
    s_add_u32 s71, s71, s82
    s_lshl_b32 s74, s68, 11
    s_add_u32 s74, s74, s24
    s_add_u32 s68, s5, 3
    s_and_b32 s68, s68, 3
    s_lshl_b32 s72, s68, 15
    s_add_u32 s72, s72, s82
    s_lshl_b32 s75, s68, 11
    s_add_u32 s75, s75, s24
    v_mov_b32 v64, 0
    v_mov_b32 v65, 0
    v_mov_b32 v66, 0
    v_mov_b32 v67, 0
    v_mov_b32 v68, 0
    v_mov_b32 v69, 0
    v_mov_b32 v70, 0
    v_mov_b32 v71, 0
    v_mov_b32 v72, 0
    v_mov_b32 v73, 0
    v_mov_b32 v74, 0
    v_mov_b32 v75, 0
    v_mov_b32 v76, 0
    v_mov_b32 v77, 0
    v_mov_b32 v78, 0
    v_mov_b32 v79, 0
    v_mov_b32 v80, 0
    v_mov_b32 v81, 0
    v_mov_b32 v82, 0
    v_mov_b32 v83, 0
    v_mov_b32 v84, 0
    v_mov_b32 v85, 0
    v_mov_b32 v86, 0
    v_mov_b32 v87, 0
    v_mov_b32 v88, 0
    v_mov_b32 v89, 0
    v_mov_b32 v90, 0
    v_mov_b32 v91, 0
    v_mov_b32 v92, 0
    v_mov_b32 v93, 0
    v_mov_b32 v94, 0
    v_mov_b32 v95, 0
    v_mov_b32 v96, 0
    v_mov_b32 v97, 0
    v_mov_b32 v98, 0
    v_mov_b32 v99, 0
    v_mov_b32 v100, 0
    v_mov_b32 v101, 0
    v_mov_b32 v102, 0
    v_mov_b32 v103, 0
    v_mov_b32 v104, 0
    v_mov_b32 v105, 0
    v_mov_b32 v106, 0
    v_mov_b32 v107, 0
    v_mov_b32 v108, 0
    v_mov_b32 v109, 0
    v_mov_b32 v110, 0
    v_mov_b32 v111, 0
    v_mov_b32 v112, 0
    v_mov_b32 v113, 0
    v_mov_b32 v114, 0
    v_mov_b32 v115, 0
    v_mov_b32 v116, 0
    v_mov_b32 v117, 0
    v_mov_b32 v118, 0
    v_mov_b32 v119, 0
    v_mov_b32 v120, 0
    v_mov_b32 v121, 0
    v_mov_b32 v122, 0
    v_mov_b32 v123, 0
    v_mov_b32 v124, 0
    v_mov_b32 v125, 0
    v_mov_b32 v126, 0
    v_mov_b32 v127, 0
    s_mov_b32 s39, 33824
    s_movk_i32 s27, 0x400
    s_cmp_eq_u32 s3, 0
    s_cselect_b32 s30, 0, 3
    s_mov_b32 s31, 0
    s_add_u32 s29, s5, 1
    s_or_b32 s80, s5, s3
    s_cmp_lg_u32 s80, 0
    s_cbranch_scc1 L_e0_15
    s_call_b64 s[88:89], L_el_vote
L_e0_15:
    s_waitcnt vmcnt(0)
    s_add_u32 s8, s54, s22
    s_addc_u32 s9, s55, 0
    s_barrier
    ds_read_b32 v14, v10
    v_add_u32 v10, s39, v10
    ds_read_b128 v[160:163], v1 offset:0
    ds_read_b128 v[164:167], v1 offset:32
    ds_read_b128 v[168:171], v1 offset:64
    ds_read_b128 v[172:175], v1 offset:96
    ds_read_b128 v[176:179], v1 offset:128
    ds_read_b128 v[180:183], v1 offset:160
    ds_read_b128 v[184:187], v1 offset:192
    ds_read_b128 v[188:191], v1 offset:224
    ds_read_b128 v[192:195], v1 offset:8704
    ds_read_b128 v[196:199], v1 offset:8736
    ds_read_b128 v[200:203], v1 offset:8768
    ds_read_b128 v[204:207], v1 offset:8800
    ds_read_b128 v[208:211], v1 offset:8832
    ds_read_b128 v[212:215], v1 offset:8864
    ds_read_b128 v[216:219], v1 offset:8896
    ds_read_b128 v[220:223], v1 offset:8928
    s_waitcnt lgkmcnt(14)
    v_mfma_f32_32x32x16_bf16 v[224:239], v[160:163], v[128:131], v[32:47]
    s_waitcnt lgkmcnt(14)
    v_mfma_f32_32x32x16_bf16 v[224:239], v[164:167], v[132:135], v[224:239]
    s_waitcnt lgkmcnt(13)
    v_mfma_f32_32x32x16_bf16 v[224:239], v[168:171], v[136:139], v[224:239]
    s_waitcnt lgkmcnt(12)
    v_mfma_f32_32x32x16_bf16 v[224:239], v[172:175], v[140:143], v[224:239]
    s_waitcnt lgkmcnt(11)
    v_mfma_f32_32x32x16_bf16 v[224:239], v[176:179], v[144:147], v[224:239]
    s_waitcnt lgkmcnt(10)
    v_mfma_f32_32x32x16_bf16 v[224:239], v[180:183], v[148:151], v[224:239]
    s_waitcnt lgkmcnt(9)
    v_mfma_f32_32x32x16_bf16 v[224:239], v[184:187], v[152:155], v[224:239]
    s_waitcnt lgkmcnt(8)
    v_mfma_f32_32x32x16_bf16 v[224:239], v[188:191], v[156:159], v[224:239]
    s_waitcnt lgkmcnt(7)
    v_mfma_f32_32x32x16_bf16 v[240:255], v[192:195], v[128:131], v[32:47]
    s_waitcnt lgkmcnt(6)
    v_mfma_f32_32x32x16_bf16 v[240:255], v[196:199], v[132:135], v[240:255]
    s_waitcnt lgkmcnt(5)
    v_mfma_f32_32x32x16_bf16 v[240:255], v[200:203], v[136:139], v[240:255]
    s_waitcnt lgkmcnt(4)
    v_mfma_f32_32x32x16_bf16 v[240:255], v[204:207], v[140:143], v[240:255]
    s_waitcnt lgkmcnt(3)
    v_mfma_f32_32x32x16_bf16 v[240:255], v[208:211], v[144:147], v[240:255]
    s_waitcnt lgkmcnt(2)
    v_mfma_f32_32x32x16_bf16 v[240:255], v[212:215], v[148:151], v[240:255]
    s_waitcnt lgkmcnt(1)
    v_mfma_f32_32x32x16_bf16 v[240:255], v[216:219], v[152:155], v[240:255]
    s_waitcnt lgkmcnt(0)
    v_mfma_f32_32x32x16_bf16 v[240:255], v[220:223], v[156:159], v[240:255]
    s_nop 7
    s_nop 3
    v_max3_f32 v6, v224, v225, v226
    v_max3_f32 v6, v6, v227, v228
    v_max3_f32 v6, v6, v229, v230
    v_max3_f32 v6, v6, v231, v232
    v_max3_f32 v6, v6, v233, v234
    v_max3_f32 v6, v6, v235, v236
    v_max3_f32 v6, v6, v237, v238
    v_max3_f32 v6, v6, v239, v240
    v_max3_f32 v6, v6, v241, v242
    v_max3_f32 v6, v6, v243, v244
    v_max3_f32 v6, v6, v245, v246
    v_max3_f32 v6, v6, v247, v248
    v_max3_f32 v6, v6, v249, v250
    v_max3_f32 v6, v6, v251, v252
    v_max3_f32 v6, v6, v253, v254
    v_max_f32 v6, v6, v255
    v_mov_b32 v7, v6
    s_nop 1
    v_permlane32_swap_b32 v6, v7
    v_max_f32 v6, v6, v7
    v_sub_f32 v32, v32, v6
    v_sub_f32 v33, v33, v6
    v_sub_f32 v34, v34, v6
    v_sub_f32 v35, v35, v6
    v_sub_f32 v36, v36, v6
    v_sub_f32 v37, v37, v6
    v_sub_f32 v38, v38, v6
    v_sub_f32 v39, v39, v6
    v_sub_f32 v40, v40, v6
    v_sub_f32 v41, v41, v6
    v_sub_f32 v42, v42, v6
    v_sub_f32 v43, v43, v6
    v_sub_f32 v44, v44, v6
    v_sub_f32 v45, v45, v6
    v_sub_f32 v46, v46, v6
    v_sub_f32 v47, v47, v6
    v_sub_f32 v224, v224, v6
    v_sub_f32 v225, v225, v6
    v_sub_f32 v226, v226, v6
    v_sub_f32 v227, v227, v6
    v_sub_f32 v228, v228, v6
    v_sub_f32 v229, v229, v6
    v_sub_f32 v230, v230, v6
    v_sub_f32 v231, v231, v6
    v_sub_f32 v232, v232, v6
    v_sub_f32 v233, v233, v6
    v_sub_f32 v234, v234, v6
    v_sub_f32 v235, v235, v6
    v_sub_f32 v236, v236, v6
    v_sub_f32 v237, v237, v6
    v_sub_f32 v238, v238, v6
    v_sub_f32 v239, v239, v6
    v_sub_f32 v240, v240, v6
    v_sub_f32 v241, v241, v6
    v_sub_f32 v242, v242, v6
    v_sub_f32 v243, v243, v6
    v_sub_f32 v244, v244, v6
    v_sub_f32 v245, v245, v6
    v_sub_f32 v246, v246, v6
    v_sub_f32 v247, v247, v6
    v_sub_f32 v248, v248, v6
    v_sub_f32 v249, v249, v6
    v_sub_f32 v250, v250, v6
    v_sub_f32 v251, v251, v6
    v_sub_f32 v252, v252, v6
    v_sub_f32 v253, v253, v6
    v_sub_f32 v254, v254, v6
    v_sub_f32 v255, v255, v6
    v_exp_f32 v224, v224
    v_exp_f32 v225, v225
    v_exp_f32 v226, v226
    v_exp_f32 v227, v227
    v_exp_f32 v228, v228
    v_exp_f32 v229, v229
    v_exp_f32 v230, v230
    v_exp_f32 v231, v231
    v_exp_f32 v232, v232
    v_exp_f32 v233, v233
    v_exp_f32 v234, v234
    v_exp_f32 v235, v235
    v_exp_f32 v236, v236
    v_exp_f32 v237, v237
    v_exp_f32 v238, v238
    v_exp_f32 v239, v239
    v_exp_f32 v240, v240
    v_exp_f32 v241, v241
    v_exp_f32 v242, v242
    v_exp_f32 v243, v243
    v_exp_f32 v244, v244
    v_exp_f32 v245, v245
    v_exp_f32 v246, v246
    v_exp_f32 v247, v247
    v_exp_f32 v248, v248
    v_exp_f32 v249, v249
    v_exp_f32 v250, v250
    v_exp_f32 v251, v251
    v_exp_f32 v252, v252
    v_exp_f32 v253, v253
    v_exp_f32 v254, v254
    v_exp_f32 v255, v255
    v_add_f32 v7, v224, v225
    v_add_f32 v8, v226, v227
    v_add_f32 v7, v7, v228
    v_add_f32 v8, v8, v229
    v_add_f32 v7, v7, v230
    v_add_f32 v8, v8, v231
    v_add_f32 v7, v7, v232
    v_add_f32 v8, v8, v233
    v_add_f32 v7, v7, v234
    v_add_f32 v8, v8, v235
    v_add_f32 v7, v7, v236
    v_add_f32 v8, v8, v237
    v_add_f32 v7, v7, v238
    v_add_f32 v8, v8, v239
    v_add_f32 v7, v7, v240
    v_add_f32 v8, v8, v241
    v_add_f32 v7, v7, v242
    v_add_f32 v8, v8, v243
    v_add_f32 v7, v7, v244
    v_add_f32 v8, v8, v245
    v_add_f32 v7, v7, v246
    v_add_f32 v8, v8, v247
    v_add_f32 v7, v7, v248
    v_add_f32 v8, v8, v249
    v_add_f32 v7, v7, v250
    v_add_f32 v8, v8, v251
    v_add_f32 v7, v7, v252
    v_add_f32 v8, v8, v253
    v_add_f32 v7, v7, v254
    v_add_f32 v8, v8, v255
    v_cvt_pk_bf16_f32 v16, v224, v225
    v_cvt_pk_bf16_f32 v17, v226, v227
    v_cvt_pk_bf16_f32 v18, v228, v229
    v_cvt_pk_bf16_f32 v19, v230, v231
    v_cvt_pk_bf16_f32 v20, v232, v233
    v_cvt_pk_bf16_f32 v21, v234, v235
    v_cvt_pk_bf16_f32 v22, v236, v237
    v_cvt_pk_bf16_f32 v23, v238, v239
    v_cvt_pk_bf16_f32 v24, v240, v241
    v_cvt_pk_bf16_f32 v25, v242, v243
    v_cvt_pk_bf16_f32 v26, v244, v245
    v_cvt_pk_bf16_f32 v27, v246, v247
    v_cvt_pk_bf16_f32 v28, v248, v249
    v_cvt_pk_bf16_f32 v29, v250, v251
    v_cvt_pk_bf16_f32 v30, v252, v253
    v_cvt_pk_bf16_f32 v31, v254, v255
    v_add_f32 v7, v7, v8
    v_mov_b32 v4, v7
    v_add_u32 v1, s39, v1
    v_add_u32 v2, s39, v2
    s_waitcnt lgkmcnt(0)
    v_readfirstlane_b32 s28, v14
    s_sub_u32 s39, 0, s39
    s_and_b32 s28, s28, 0xffff
    s_cmp_eq_u32 s30, 3
    s_cbranch_scc1 L_el_16
    s_call_b64 s[88:89], L_elect
L_el_16:
L_cloop:
    s_barrier
    s_cmp_lt_u32 s28, 0x100
    s_cbranch_scc1 L_clast
    ds_read_b128 v[160:163], v1 offset:0
    ds_read_b128 v[164:167], v1 offset:32
    ds_read_b128 v[168:171], v1 offset:64
    ds_read_b128 v[172:175], v1 offset:96
    ds_read_b128 v[176:179], v1 offset:128
    ds_read_b128 v[180:183], v1 offset:160
    ds_read_b32 v14, v10
    v_add_u32 v10, s39, v10
    s_cmp_eq_u32 s26, 0
    s_cbranch_scc1 L_rs_17
    v_mul_f32 v64, v5, v64
    v_mul_f32 v65, v5, v65
    v_mul_f32 v66, v5, v66
    v_mul_f32 v67, v5, v67
    v_mul_f32 v68, v5, v68
    v_mul_f32 v69, v5, v69
    v_mul_f32 v70, v5, v70
    v_mul_f32 v71, v5, v71
    v_mul_f32 v72, v5, v72
    v_mul_f32 v73, v5, v73
    v_mul_f32 v74, v5, v74
    v_mul_f32 v75, v5, v75
    v_mul_f32 v76, v5, v76
    v_mul_f32 v77, v5, v77
    v_mul_f32 v78, v5, v78
    v_mul_f32 v79, v5, v79
    v_mul_f32 v80, v5, v80
    v_mul_f32 v81, v5, v81
    v_mul_f32 v82, v5, v82
    v_mul_f32 v83, v5, v83
    v_mul_f32 v84, v5, v84
    v_mul_f32 v85, v5, v85
    v_mul_f32 v86, v5, v86
    v_mul_f32 v87, v5, v87
    v_mul_f32 v88, v5, v88
    v_mul_f32 v89, v5, v89
    v_mul_f32 v90, v5, v90
    v_mul_f32 v91, v5, v91
    v_mul_f32 v92, v5, v92
    v_mul_f32 v93, v5, v93
    v_mul_f32 v94, v5, v94
    v_mul_f32 v95, v5, v95
    v_mul_f32 v96, v5, v96
    v_mul_f32 v97, v5, v97
    v_mul_f32 v98, v5, v98
    v_mul_f32 v99, v5, v99
    v_mul_f32 v100, v5, v100
    v_mul_f32 v101, v5, v101
    v_mul_f32 v102, v5, v102
    v_mul_f32 v103, v5, v103
    v_mul_f32 v104, v5, v104
    v_mul_f32 v105, v5, v105
    v_mul_f32 v106, v5, v106
    v_mul_f32 v107, v5, v107
    v_mul_f32 v108, v5, v108
    v_mul_f32 v109, v5, v109
    v_mul_f32 v110, v5, v110
    v_mul_f32 v111, v5, v111
    v_mul_f32 v112, v5, v112
    v_mul_f32 v113, v5, v113
    v_mul_f32 v114, v5, v114
    v_mul_f32 v115, v5, v115
    v_mul_f32 v116, v5, v116
    v_mul_f32 v117, v5, v117
    v_mul_f32 v118, v5, v118
    v_mul_f32 v119, v5, v119
    v_mul_f32 v120, v5, v120
    v_mul_f32 v121, v5, v121
    v_mul_f32 v122, v5, v122
    v_mul_f32 v123, v5, v123
    v_mul_f32 v124, v5, v124
    v_mul_f32 v125, v5, v125
    v_mul_f32 v126, v5, v126
    v_mul_f32 v127, v5, v127
    s_mov_b32 s26, 0
L_rs_17:
    s_waitcnt lgkmcnt(6)
    v_mfma_f32_32x32x16_bf16 v[224:239], v[160:163], v[128:131], v[32:47]
    ds_read_b128 v[184:187], v1 offset:192
    s_waitcnt lgkmcnt(6)
    v_mfma_f32_32x32x16_bf16 v[224:239], v[164:167], v[132:135], v[224:239]
    ds_read_b128 v[188:191], v1 offset:224
    s_waitcnt lgkmcnt(6)
    v_mfma_f32_32x32x16_bf16 v[224:239], v[168:171], v[136:139], v[224:239]
    ds_read_b128 v[192:195], v1 offset:8704
    s_waitcnt lgkmcnt(6)
    v_mfma_f32_32x32x16_bf16 v[224:239], v[172:175], v[140:143], v[224:239]
    ds_read_b128 v[196:199], v1 offset:8736
    s_waitcnt lgkmcnt(6)
    v_mfma_f32_32x32x16_bf16 v[224:239], v[176:179], v[144:147], v[224:239]
    ds_read_b128 v[200:203], v1 offset:8768
    s_waitcnt lgkmcnt(6)
    v_mfma_f32_32x32x16_bf16 v[224:239], v[180:183], v[148:151], v[224:239]
    ds_read_b128 v[204:207], v1 offset:8800
    s_waitcnt lgkmcnt(5)
    v_mfma_f32_32x32x16_bf16 v[224:239], v[184:187], v[152:155], v[224:239]
    ds_read_b128 v[208:211], v1 offset:8832
    s_waitcnt lgkmcnt(5)
    v_mfma_f32_32x32x16_bf16 v[224:239], v[188:191], v[156:159], v[224:239]
    ds_read_b128 v[212:215], v1 offset:8864
    s_waitcnt lgkmcnt(5)
    v_mfma_f32_32x32x16_bf16 v[240:255], v[192:195], v[128:131], v[32:47]
    ds_read_b128 v[216:219], v1 offset:8896
    s_waitcnt lgkmcnt(5)
    v_mfma_f32_32x32x16_bf16 v[240:255], v[196:199], v[132:135], v[240:255]
    ds_read_b128 v[220:223], v1 offset:8928
    s_waitcnt lgkmcnt(5)
    v_mfma_f32_32x32x16_bf16 v[240:255], v[200:203], v[136:139], v[240:255]
    ds_read_b128 v[160:163], v2 offset:17408
    s_waitcnt lgkmcnt(5)
    v_mfma_f32_32x32x16_bf16 v[240:255], v[204:207], v[140:143], v[240:255]
    ds_read_b128 v[164:167], v2 offset:18432
    v_exp_f32 v224, v224
    v_exp_f32 v225, v225
    s_waitcnt lgkmcnt(5)
    v_mfma_f32_32x32x16_bf16 v[240:255], v[208:211], v[144:147], v[240:255]
    ds_read_b128 v[168:171], v2 offset:19456
    v_exp_f32 v226, v226
    v_exp_f32 v227, v227
    s_waitcnt lgkmcnt(5)
    v_mfma_f32_32x32x16_bf16 v[240:255], v[212:215], v[148:151], v[240:255]
    ds_read_b128 v[172:175], v2 offset:20480
    v_exp_f32 v228, v228
    v_exp_f32 v229, v229
    s_waitcnt lgkmcnt(5)
    v_mfma_f32_32x32x16_bf16 v[240:255], v[216:219], v[152:155], v[240:255]
    ds_read_b128 v[176:179], v2 offset:21504
    v_exp_f32 v230, v230
    v_exp_f32 v231, v231
    s_waitcnt lgkmcnt(5)
    v_mfma_f32_32x32x16_bf16 v[240:255], v[220:223], v[156:159], v[240:255]
    ds_read_b128 v[180:183], v2 offset:22528
    v_exp_f32 v232, v232
    v_exp_f32 v233, v233
    s_waitcnt lgkmcnt(5)
    v_mfma_f32_32x32x16_bf16 v[64:79], v[160:163], v[16:19], v[64:79]
    ds_read_b128 v[184:187], v2 offset:23552
    v_exp_f32 v234, v234
    v_exp_f32 v235, v235
    v_exp_f32 v236, v236
    s_waitcnt lgkmcnt(5)
    v_mfma_f32_32x32x16_bf16 v[80:95], v[164:167], v[16:19], v[80:95]
    ds_read_b128 v[188:191], v2 offset:24576
    v_exp_f32 v237, v237
    v_exp_f32 v238, v238
    v_exp_f32 v239, v239
    s_waitcnt lgkmcnt(5)
    v_mfma_f32_32x32x16_bf16 v[96:111], v[168:171], v[16:19], v[96:111]
    ds_read_b128 v[192:195], v2 offset:25600
    v_add_f32 v7, v224, v225
    v_add_f32 v8, v226, v227
    v_add_f32 v7, v7, v228
    v_add_f32 v8, v8, v229
    v_add_f32 v7, v7, v230
    v_add_f32 v8, v8, v231
    s_waitcnt lgkmcnt(5)
    v_mfma_f32_32x32x16_bf16 v[112:127], v[172:175], v[16:19], v[112:127]
    ds_read_b128 v[196:199], v2 offset:26624
    v_add_f32 v7, v7, v232
    v_add_f32 v8, v8, v233
    v_add_f32 v7, v7, v234
    v_add_f32 v8, v8, v235
    v_add_f32 v7, v7, v236
    s_waitcnt lgkmcnt(5)
    v_mfma_f32_32x32x16_bf16 v[64:79], v[176:179], v[20:23], v[64:79]
    ds_read_b128 v[200:203], v2 offset:27648
    v_add_f32 v8, v8, v237
    v_add_f32 v7, v7, v238
    v_add_f32 v8, v8, v239
    s_cmp_ge_u32 s28, 0x400
    s_cbranch_scc1 L_mk_18
    v_mov_b32 v240, 0xf149f2ca
    v_mov_b32 v241, 0xf149f2ca
    v_mov_b32 v242, 0xf149f2ca
    v_mov_b32 v243, 0xf149f2ca
    v_mov_b32 v244, 0xf149f2ca
    v_mov_b32 v245, 0xf149f2ca
    v_mov_b32 v246, 0xf149f2ca
    v_mov_b32 v247, 0xf149f2ca
    v_mov_b32 v248, 0xf149f2ca
    v_mov_b32 v249, 0xf149f2ca
    v_mov_b32 v250, 0xf149f2ca
    v_mov_b32 v251, 0xf149f2ca
    v_mov_b32 v252, 0xf149f2ca
    v_mov_b32 v253, 0xf149f2ca
    v_mov_b32 v254, 0xf149f2ca
    v_mov_b32 v255, 0xf149f2ca
L_mk_18:
    v_exp_f32 v240, v240
    v_exp_f32 v241, v241
    s_waitcnt lgkmcnt(5)
    v_mfma_f32_32x32x16_bf16 v[80:95], v[180:183], v[20:23], v[80:95]
    ds_read_b128 v[204:207], v2 offset:28672
    v_exp_f32 v242, v242
    v_exp_f32 v243, v243
    v_exp_f32 v244, v244
    s_waitcnt lgkmcnt(5)
    v_mfma_f32_32x32x16_bf16 v[96:111], v[184:187], v[20:23], v[96:111]
    ds_read_b128 v[208:211], v2 offset:29696
    v_exp_f32 v245, v245
    v_exp_f32 v246, v246
    v_exp_f32 v247, v247
    s_waitcnt lgkmcnt(5)
    v_mfma_f32_32x32x16_bf16 v[112:127], v[188:191], v[20:23], v[112:127]
    ds_read_b128 v[212:215], v2 offset:30720
    v_cvt_pk_bf16_f32 v16, v224, v225
    v_cvt_pk_bf16_f32 v17, v226, v227
    v_cvt_pk_bf16_f32 v18, v228, v229
    v_cvt_pk_bf16_f32 v19, v230, v231
    s_waitcnt lgkmcnt(5)
    v_mfma_f32_32x32x16_bf16 v[64:79], v[192:195], v[24:27], v[64:79]
    ds_read_b128 v[216:219], v2 offset:31744
    v_exp_f32 v248, v248
    v_exp_f32 v249, v249
    v_exp_f32 v250, v250
    s_waitcnt lgkmcnt(5)
    v_mfma_f32_32x32x16_bf16 v[80:95], v[196:199], v[24:27], v[80:95]
    ds_read_b128 v[220:223], v2 offset:32768
    v_exp_f32 v251, v251
    v_exp_f32 v252, v252
    v_exp_f32 v253, v253
    s_waitcnt lgkmcnt(5)
    v_mfma_f32_32x32x16_bf16 v[96:111], v[200:203], v[24:27], v[96:111]
    v_exp_f32 v254, v254
    v_exp_f32 v255, v255
    v_cvt_pk_bf16_f32 v20, v232, v233
    v_cvt_pk_bf16_f32 v21, v234, v235
    s_waitcnt lgkmcnt(4)
    v_mfma_f32_32x32x16_bf16 v[112:127], v[204:207], v[24:27], v[112:127]
    v_cvt_pk_bf16_f32 v22, v236, v237
    v_cvt_pk_bf16_f32 v23, v238, v239
    v_add_f32 v7, v7, v240
    v_add_f32 v8, v8, v241
    v_add_f32 v7, v7, v242
    s_waitcnt lgkmcnt(3)
    v_mfma_f32_32x32x16_bf16 v[64:79], v[208:211], v[28:31], v[64:79]
    v_add_f32 v8, v8, v243
    v_add_f32 v7, v7, v244
    v_add_f32 v8, v8, v245
    v_add_f32 v7, v7, v246
    v_add_f32 v8, v8, v247
    v_add_f32 v7, v7, v248
    s_waitcnt lgkmcnt(2)
    v_mfma_f32_32x32x16_bf16 v[80:95], v[212:215], v[28:31], v[80:95]
    v_add_f32 v8, v8, v249
    v_add_f32 v7, v7, v250
    v_add_f32 v8, v8, v251
    v_add_f32 v7, v7, v252
    v_add_f32 v8, v8, v253
    v_add_f32 v7, v7, v254
    s_waitcnt lgkmcnt(1)
    v_mfma_f32_32x32x16_bf16 v[96:111], v[216:219], v[28:31], v[96:111]
    v_add_f32 v8, v8, v255
    v_cvt_pk_bf16_f32 v24, v240, v241
    v_cvt_pk_bf16_f32 v25, v242, v243
    v_cvt_pk_bf16_f32 v26, v244, v245
    v_cvt_pk_bf16_f32 v27, v246, v247
    v_add_f32 v7, v7, v8
    s_waitcnt lgkmcnt(0)
    v_mfma_f32_32x32x16_bf16 v[112:127], v[220:223], v[28:31], v[112:127]
    v_cmp_nle_f32 vcc, v7, v13
    v_cvt_pk_bf16_f32 v28, v248, v249
    v_cvt_pk_bf16_f32 v29, v250, v251
    v_cvt_pk_bf16_f32 v30, v252, v253
    v_cvt_pk_bf16_f32 v31, v254, v255
    s_cbranch_vccnz L_cslowmax
L_cback:
    v_add_f32 v4, v4, v7
    v_add_u32 v1, s39, v1
    v_add_u32 v2, s39, v2
    s_waitcnt lgkmcnt(0)
    v_readfirstlane_b32 s28, v14
    s_sub_u32 s39, 0, s39
    s_and_b32 s28, s28, 0xffff
    s_cmp_eq_u32 s30, 3
    s_cbranch_scc1 L_el_19
    s_call_b64 s[88:89], L_elect
L_el_19:
    s_branch L_cloop
L_cslowmax:
    ds_read_b128 v[160:163], v1 offset:0
    ds_read_b128 v[164:167], v1 offset:32
    ds_read_b128 v[168:171], v1 offset:64
    ds_read_b128 v[172:175], v1 offset:96
    ds_read_b128 v[176:179], v1 offset:128
    ds_read_b128 v[180:183], v1 offset:160
    ds_read_b128 v[184:187], v1 offset:192
    ds_read_b128 v[188:191], v1 offset:224
    ds_read_b128 v[192:195], v1 offset:8704
    ds_read_b128 v[196:199], v1 offset:8736
    ds_read_b128 v[200:203], v1 offset:8768
    ds_read_b128 v[204:207], v1 offset:8800
    ds_read_b128 v[208:211], v1 offset:8832
    ds_read_b128 v[212:215], v1 offset:8864
    ds_read_b128 v[216:219], v1 offset:8896
    ds_read_b128 v[220:223], v1 offset:8928
    s_waitcnt lgkmcnt(14)
    v_mfma_f32_32x32x16_bf16 v[224:239], v[160:163], v[128:131], v[32:47]
    s_waitcnt lgkmcnt(14)
    v_mfma_f32_32x32x16_bf16 v[224:239], v[164:167], v[132:135], v[224:239]
    s_waitcnt lgkmcnt(13)
    v_mfma_f32_32x32x16_bf16 v[224:239], v[168:171], v[136:139], v[224:239]
    s_waitcnt lgkmcnt(12)
    v_mfma_f32_32x32x16_bf16 v[224:239], v[172:175], v[140:143], v[224:239]
    s_waitcnt lgkmcnt(11)
    v_mfma_f32_32x32x16_bf16 v[224:239], v[176:179], v[144:147], v[224:239]
    s_waitcnt lgkmcnt(10)
    v_mfma_f32_32x32x16_bf16 v[224:239], v[180:183], v[148:151], v[224:239]
    s_waitcnt lgkmcnt(9)
    v_mfma_f32_32x32x16_bf16 v[224:239], v[184:187], v[152:155], v[224:239]
    s_waitcnt lgkmcnt(8)
    v_mfma_f32_32x32x16_bf16 v[224:239], v[188:191], v[156:159], v[224:239]
    s_waitcnt lgkmcnt(7)
    v_mfma_f32_32x32x16_bf16 v[240:255], v[192:195], v[128:131], v[32:47]
    s_waitcnt lgkmcnt(6)
    v_mfma_f32_32x32x16_bf16 v[240:255], v[196:199], v[132:135], v[240:255]
    s_waitcnt lgkmcnt(5)
    v_mfma_f32_32x32x16_bf16 v[240:255], v[200:203], v[136:139], v[240:255]
    s_waitcnt lgkmcnt(4)
    v_mfma_f32_32x32x16_bf16 v[240:255], v[204:207], v[140:143], v[240:255]
    s_waitcnt lgkmcnt(3)
    v_mfma_f32_32x32x16_bf16 v[240:255], v[208:211], v[144:147], v[240:255]
    s_waitcnt lgkmcnt(2)
    v_mfma_f32_32x32x16_bf16 v[240:255], v[212:215], v[148:151], v[240:255]
    s_waitcnt lgkmcnt(1)
    v_mfma_f32_32x32x16_bf16 v[240:255], v[216:219], v[152:155], v[240:255]
    s_waitcnt lgkmcnt(0)
    v_mfma_f32_32x32x16_bf16 v[240:255], v[220:223], v[156:159], v[240:255]
    s_nop 7
    s_nop 3
    s_cmp_ge_u32 s28, 0x400
    s_cbranch_scc1 L_mk_20
    v_mov_b32 v240, 0xf149f2ca
    v_mov_b32 v241, 0xf149f2ca
    v_mov_b32 v242, 0xf149f2ca
    v_mov_b32 v243, 0xf149f2ca
    v_mov_b32 v244, 0xf149f2ca
    v_mov_b32 v245, 0xf149f2ca
    v_mov_b32 v246, 0xf149f2ca
    v_mov_b32 v247, 0xf149f2ca
    v_mov_b32 v248, 0xf149f2ca
    v_mov_b32 v249, 0xf149f2ca
    v_mov_b32 v250, 0xf149f2ca
    v_mov_b32 v251, 0xf149f2ca
    v_mov_b32 v252, 0xf149f2ca
    v_mov_b32 v253, 0xf149f2ca
    v_mov_b32 v254, 0xf149f2ca
    v_mov_b32 v255, 0xf149f2ca
L_mk_20:
    v_max3_f32 v6, v224, v225, v226
    v_max3_f32 v6, v6, v227, v228
    v_max3_f32 v6, v6, v229, v230
    v_max3_f32 v6, v6, v231, v232
    v_max3_f32 v6, v6, v233, v234
    v_max3_f32 v6, v6, v235, v236
    v_max3_f32 v6, v6, v237, v238
    v_max3_f32 v6, v6, v239, v240
    v_max3_f32 v6, v6, v241, v242
    v_max3_f32 v6, v6, v243, v244
    v_max3_f32 v6, v6, v245, v246
    v_max3_f32 v6, v6, v247, v248
    v_max3_f32 v6, v6, v249, v250
    v_max3_f32 v6, v6, v251, v252
    v_max3_f32 v6, v6, v253, v254
    v_max_f32 v6, v6, v255
    v_mov_b32 v7, v6
    s_nop 1
    v_permlane32_swap_b32 v6, v7
    v_max3_f32 v6, v6, v7, 0
    v_exp_f32 v5, -v6
    v_sub_f32 v32, v32, v6
    v_sub_f32 v33, v33, v6
    v_sub_f32 v34, v34, v6
    v_sub_f32 v35, v35, v6
    v_sub_f32 v36, v36, v6
    v_sub_f32 v37, v37, v6
    v_sub_f32 v38, v38, v6
    v_sub_f32 v39, v39, v6
    v_sub_f32 v40, v40, v6
    v_sub_f32 v41, v41, v6
    v_sub_f32 v42, v42, v6
    v_sub_f32 v43, v43, v6
    v_sub_f32 v44, v44, v6
    v_sub_f32 v45, v45, v6
    v_sub_f32 v46, v46, v6
    v_sub_f32 v47, v47, v6
    v_mul_f32 v4, v4, v5
    s_mov_b32 s26, 1
    v_sub_f32 v224, v224, v6
    v_sub_f32 v225, v225, v6
    v_sub_f32 v226, v226, v6
    v_sub_f32 v227, v227, v6
    v_sub_f32 v228, v228, v6
    v_sub_f32 v229, v229, v6
    v_sub_f32 v230, v230, v6
    v_sub_f32 v231, v231, v6
    v_sub_f32 v232, v232, v6
    v_sub_f32 v233, v233, v6
    v_sub_f32 v234, v234, v6
    v_sub_f32 v235, v235, v6
    v_sub_f32 v236, v236, v6
    v_sub_f32 v237, v237, v6
    v_sub_f32 v238, v238, v6
    v_sub_f32 v239, v239, v6
    v_sub_f32 v240, v240, v6
    v_sub_f32 v241, v241, v6
    v_sub_f32 v242, v242, v6
    v_sub_f32 v243, v243, v6
    v_sub_f32 v244, v244, v6
    v_sub_f32 v245, v245, v6
    v_sub_f32 v246, v246, v6
    v_sub_f32 v247, v247, v6
    v_sub_f32 v248, v248, v6
    v_sub_f32 v249, v249, v6
    v_sub_f32 v250, v250, v6
    v_sub_f32 v251, v251, v6
    v_sub_f32 v252, v252, v6
    v_sub_f32 v253, v253, v6
    v_sub_f32 v254, v254, v6
    v_sub_f32 v255, v255, v6
    v_exp_f32 v224, v224
    v_exp_f32 v225, v225
    v_exp_f32 v226, v226
    v_exp_f32 v227, v227
    v_exp_f32 v228, v228
    v_exp_f32 v229, v229
    v_exp_f32 v230, v230
    v_exp_f32 v231, v231
    v_exp_f32 v232, v232
    v_exp_f32 v233, v233
    v_exp_f32 v234, v234
    v_exp_f32 v235, v235
    v_exp_f32 v236, v236
    v_exp_f32 v237, v237
    v_exp_f32 v238, v238
    v_exp_f32 v239, v239
    v_exp_f32 v240, v240
    v_exp_f32 v241, v241
    v_exp_f32 v242, v242
    v_exp_f32 v243, v243
    v_exp_f32 v244, v244
    v_exp_f32 v245, v245
    v_exp_f32 v246, v246
    v_exp_f32 v247, v247
    v_exp_f32 v248, v248
    v_exp_f32 v249, v249
    v_exp_f32 v250, v250
    v_exp_f32 v251, v251
    v_exp_f32 v252, v252
    v_exp_f32 v253, v253
    v_exp_f32 v254, v254
    v_exp_f32 v255, v255
    v_add_f32 v7, v224, v225
    v_add_f32 v8, v226, v227
    v_add_f32 v7, v7, v228
    v_add_f32 v8, v8, v229
    v_add_f32 v7, v7, v230
    v_add_f32 v8, v8, v231
    v_add_f32 v7, v7, v232
    v_add_f32 v8, v8, v233
    v_add_f32 v7, v7, v234
    v_add_f32 v8, v8, v235
    v_add_f32 v7, v7, v236
    v_add_f32 v8, v8, v237
    v_add_f32 v7, v7, v238
    v_add_f32 v8, v8, v239
    v_add_f32 v7, v7, v240
    v_add_f32 v8, v8, v241
    v_add_f32 v7, v7, v242
    v_add_f32 v8, v8, v243
    v_add_f32 v7, v7, v244
    v_add_f32 v8, v8, v245
    v_add_f32 v7, v7, v246
    v_add_f32 v8, v8, v247
    v_add_f32 v7, v7, v248
    v_add_f32 v8, v8, v249
    v_add_f32 v7, v7, v250
    v_add_f32 v8, v8, v251
    v_add_f32 v7, v7, v252
    v_add_f32 v8, v8, v253
    v_add_f32 v7, v7, v254
    v_add_f32 v8, v8, v255
    v_cvt_pk_bf16_f32 v16, v224, v225
    v_cvt_pk_bf16_f32 v17, v226, v227
    v_cvt_pk_bf16_f32 v18, v228, v229
    v_cvt_pk_bf16_f32 v19, v230, v231
    v_cvt_pk_bf16_f32 v20, v232, v233
    v_cvt_pk_bf16_f32 v21, v234, v235
    v_cvt_pk_bf16_f32 v22, v236, v237
    v_cvt_pk_bf16_f32 v23, v238, v239
    v_cvt_pk_bf16_f32 v24, v240, v241
    v_cvt_pk_bf16_f32 v25, v242, v243
    v_cvt_pk_bf16_f32 v26, v244, v245
    v_cvt_pk_bf16_f32 v27, v246, v247
    v_cvt_pk_bf16_f32 v28, v248, v249
    v_cvt_pk_bf16_f32 v29, v250, v251
    v_cvt_pk_bf16_f32 v30, v252, v253
    v_cvt_pk_bf16_f32 v31, v254, v255
    v_add_f32 v7, v7, v8
    s_branch L_cback
L_elect:
    s_add_u32 s31, s31, 1
    s_cmp_eq_u32 s30, 0
    s_cbranch_scc1 L_el_nold
    s_waitcnt vmcnt(0)
    v_readfirstlane_b32 s80, v48
    s_bitcmp1_b32 s80, 8
    s_cselect_b32 s30, 3, 0
    s_cbranch_scc1 L_el_ret
L_el_nold:
    s_cmp_ge_u32 s31, 5
    s_cbranch_scc1 L_el_vote
    s_cmp_lt_u32 s31, s29
    s_cbranch_scc1 L_el_ret
    v_mov_b32 v49, 0
    global_load_dword v48, v49, s[76:77] sc1
    s_mov_b32 s30, 1
    s_branch L_el_ret
L_el_vote:
    s_mov_b32 s80, 1
L_el_try:
    s_atomic_add s80, s[76:77], 0 glc
    s_waitcnt lgkmcnt(0)
    s_cmp_eq_u32 s80, 0
    s_cbranch_scc1 L_el_init
    s_bitcmp1_b32 s80, 8
    s_mov_b32 s80, 0
    s_cbranch_scc0 L_el_try
    s_mov_b32 s30, 3
    s_branch L_el_ret
L_el_init:
    v_mov_b32 v48, 0
    v_mov_b32 v49, 0
    v_mov_b32 v50, 0
    v_mov_b32 v51, 0
    buffer_store_dwordx4 v[48:51], v9, s[64:67], 0 offen sc1
    s_waitcnt vmcnt(0)
    s_movk_i32 s80, 0x100
    s_atomic_add s80, s[76:77], 0
    s_mov_b32 s30, 3
L_el_ret:
    s_setpc_b64 s[88:89]
L_clast:
    ds_read_b128 v[160:163], v2 offset:17408
    ds_read_b128 v[164:167], v2 offset:18432
    ds_read_b128 v[168:171], v2 offset:19456
    ds_read_b128 v[172:175], v2 offset:20480
    ds_read_b128 v[176:179], v2 offset:21504
    ds_read_b128 v[180:183], v2 offset:22528
    s_cmp_eq_u32 s26, 0
    s_cbranch_scc1 L_rs_21
    v_mul_f32 v64, v5, v64
    v_mul_f32 v65, v5, v65
    v_mul_f32 v66, v5, v66
    v_mul_f32 v67, v5, v67
    v_mul_f32 v68, v5, v68
    v_mul_f32 v69, v5, v69
    v_mul_f32 v70, v5, v70
    v_mul_f32 v71, v5, v71
    v_mul_f32 v72, v5, v72
    v_mul_f32 v73, v5, v73
    v_mul_f32 v74, v5, v74
    v_mul_f32 v75, v5, v75
    v_mul_f32 v76, v5, v76
    v_mul_f32 v77, v5, v77
    v_mul_f32 v78, v5, v78
    v_mul_f32 v79, v5, v79
    v_mul_f32 v80, v5, v80
    v_mul_f32 v81, v5, v81
    v_mul_f32 v82, v5, v82
    v_mul_f32 v83, v5, v83
    v_mul_f32 v84, v5, v84
    v_mul_f32 v85, v5, v85
    v_mul_f32 v86, v5, v86
    v_mul_f32 v87, v5, v87
    v_mul_f32 v88, v5, v88
    v_mul_f32 v89, v5, v89
    v_mul_f32 v90, v5, v90
    v_mul_f32 v91, v5, v91
    v_mul_f32 v92, v5, v92
    v_mul_f32 v93, v5, v93
    v_mul_f32 v94, v5, v94
    v_mul_f32 v95, v5, v95
    v_mul_f32 v96, v5, v96
    v_mul_f32 v97, v5, v97
    v_mul_f32 v98, v5, v98
    v_mul_f32 v99, v5, v99
    v_mul_f32 v100, v5, v100
    v_mul_f32 v101, v5, v101
    v_mul_f32 v102, v5, v102
    v_mul_f32 v103, v5, v103
    v_mul_f32 v104, v5, v104
    v_mul_f32 v105, v5, v105
    v_mul_f32 v106, v5, v106
    v_mul_f32 v107, v5, v107
    v_mul_f32 v108, v5, v108
    v_mul_f32 v109, v5, v109
    v_mul_f32 v110, v5, v110
    v_mul_f32 v111, v5, v111
    v_mul_f32 v112, v5, v112
    v_mul_f32 v113, v5, v113
    v_mul_f32 v114, v5, v114
    v_mul_f32 v115, v5, v115
    v_mul_f32 v116, v5, v116
    v_mul_f32 v117, v5, v117
    v_mul_f32 v118, v5, v118
    v_mul_f32 v119, v5, v119
    v_mul_f32 v120, v5, v120
    v_mul_f32 v121, v5, v121
    v_mul_f32 v122, v5, v122
    v_mul_f32 v123, v5, v123
    v_mul_f32 v124, v5, v124
    v_mul_f32 v125, v5, v125
    v_mul_f32 v126, v5, v126
    v_mul_f32 v127, v5, v127
    s_mov_b32 s26, 0
L_rs_21:
    s_waitcnt lgkmcnt(5)
    v_mfma_f32_32x32x16_bf16 v[64:79], v[160:163], v[16:19], v[64:79]
    ds_read_b128 v[184:187], v2 offset:23552
    s_waitcnt lgkmcnt(5)
    v_mfma_f32_32x32x16_bf16 v[80:95], v[164:167], v[16:19], v[80:95]
    ds_read_b128 v[188:191], v2 offset:24576
    s_waitcnt lgkmcnt(5)
    v_mfma_f32_32x32x16_bf16 v[96:111], v[168:171], v[16:19], v[96:111]
    ds_read_b128 v[192:195], v2 offset:25600
    s_waitcnt lgkmcnt(5)
    v_mfma_f32_32x32x16_bf16 v[112:127], v[172:175], v[16:19], v[112:127]
    ds_read_b128 v[196:199], v2 offset:26624
    s_waitcnt lgkmcnt(5)
    v_mfma_f32_32x32x16_bf16 v[64:79], v[176:179], v[20:23], v[64:79]
    ds_read_b128 v[200:203], v2 offset:27648
    s_waitcnt lgkmcnt(5)
    v_mfma_f32_32x32x16_bf16 v[80:95], v[180:183], v[20:23], v[80:95]
    ds_read_b128 v[204:207], v2 offset:28672
    s_waitcnt lgkmcnt(5)
    v_mfma_f32_32x32x16_bf16 v[96:111], v[184:187], v[20:23], v[96:111]
    ds_read_b128 v[208:211], v2 offset:29696
    s_waitcnt lgkmcnt(5)
    v_mfma_f32_32x32x16_bf16 v[112:127], v[188:191], v[20:23], v[112:127]
    ds_read_b128 v[212:215], v2 offset:30720
    s_waitcnt lgkmcnt(5)
    v_mfma_f32_32x32x16_bf16 v[64:79], v[192:195], v[24:27], v[64:79]
    ds_read_b128 v[216:219], v2 offset:31744
    s_waitcnt lgkmcnt(5)
    v_mfma_f32_32x32x16_bf16 v[80:95], v[196:199], v[24:27], v[80:95]
    ds_read_b128 v[220:223], v2 offset:32768
    s_waitcnt lgkmcnt(5)
    v_mfma_f32_32x32x16_bf16 v[96:111], v[200:203], v[24:27], v[96:111]
    s_waitcnt lgkmcnt(4)
    v_mfma_f32_32x32x16_bf16 v[112:127], v[204:207], v[24:27], v[112:127]
    s_waitcnt lgkmcnt(3)
    v_mfma_f32_32x32x16_bf16 v[64:79], v[208:211], v[28:31], v[64:79]
    s_waitcnt lgkmcnt(2)
    v_mfma_f32_32x32x16_bf16 v[80:95], v[212:215], v[28:31], v[80:95]
    s_waitcnt lgkmcnt(1)
    v_mfma_f32_32x32x16_bf16 v[96:111], v[216:219], v[28:31], v[96:111]
    s_waitcnt lgkmcnt(0)
    v_mfma_f32_32x32x16_bf16 v[112:127], v[220:223], v[28:31], v[112:127]
    v_sub_f32 v3, 0, v32
    v_mov_b32 v7, v4
    v_mov_b32 v28, v12
    v_mov_b32 v12, v3
    v_permlane32_swap_b32 v4, v7
    v_add_f32 v13, v4, v7
    buffer_store_dwordx2 v[12:13], v15, s[16:19], s25 offen sc1
    v_add_u32 v14, 0x1000, v9
    s_nop 4
    s_cmp_eq_u32 s5, 0
    s_cbranch_scc1 L_pq_22
    v_cvt_pk_bf16_f32 v128, v64, v80
    v_cvt_pk_bf16_f32 v129, v96, v112
    v_cvt_pk_bf16_f32 v130, v65, v81
    v_cvt_pk_bf16_f32 v131, v97, v113
    v_cvt_pk_bf16_f32 v132, v66, v82
    v_cvt_pk_bf16_f32 v133, v98, v114
    v_cvt_pk_bf16_f32 v134, v67, v83
    v_cvt_pk_bf16_f32 v135, v99, v115
    buffer_store_dwordx4 v[128:131], v9, s[12:15], s21 offen offset:0 sc1
    buffer_store_dwordx4 v[132:135], v9, s[12:15], s21 offen offset:1024 sc1
L_pq_22:
    s_cmp_eq_u32 s5, 1
    s_cbranch_scc1 L_pq_23
    v_cvt_pk_bf16_f32 v136, v68, v84
    v_cvt_pk_bf16_f32 v137, v100, v116
    v_cvt_pk_bf16_f32 v138, v69, v85
    v_cvt_pk_bf16_f32 v139, v101, v117
    v_cvt_pk_bf16_f32 v140, v70, v86
    v_cvt_pk_bf16_f32 v141, v102, v118
    v_cvt_pk_bf16_f32 v142, v71, v87
    v_cvt_pk_bf16_f32 v143, v103, v119
    buffer_store_dwordx4 v[136:139], v9, s[12:15], s21 offen offset:2048 sc1
    buffer_store_dwordx4 v[140:143], v9, s[12:15], s21 offen offset:3072 sc1
L_pq_23:
    s_cmp_eq_u32 s5, 2
    s_cbranch_scc1 L_pq_24
    v_cvt_pk_bf16_f32 v144, v72, v88
    v_cvt_pk_bf16_f32 v145, v104, v120
    v_cvt_pk_bf16_f32 v146, v73, v89
    v_cvt_pk_bf16_f32 v147, v105, v121
    v_cvt_pk_bf16_f32 v148, v74, v90
    v_cvt_pk_bf16_f32 v149, v106, v122
    v_cvt_pk_bf16_f32 v150, v75, v91
    v_cvt_pk_bf16_f32 v151, v107, v123
    buffer_store_dwordx4 v[144:147], v14, s[12:15], s21 offen offset:0 sc1
    buffer_store_dwordx4 v[148:151], v14, s[12:15], s21 offen offset:1024 sc1
L_pq_24:
    s_cmp_eq_u32 s5, 3
    s_cbranch_scc1 L_pq_25
    v_cvt_pk_bf16_f32 v152, v76, v92
    v_cvt_pk_bf16_f32 v153, v108, v124
    v_cvt_pk_bf16_f32 v154, v77, v93
    v_cvt_pk_bf16_f32 v155, v109, v125
    v_cvt_pk_bf16_f32 v156, v78, v94
    v_cvt_pk_bf16_f32 v157, v110, v126
    v_cvt_pk_bf16_f32 v158, v79, v95
    v_cvt_pk_bf16_f32 v159, v111, v127
    buffer_store_dwordx4 v[152:155], v14, s[12:15], s21 offen offset:2048 sc1
    buffer_store_dwordx4 v[156:159], v14, s[12:15], s21 offen offset:3072 sc1
L_pq_25:
    s_mov_b32 s84, 300
    s_mov_b32 s83, 1
    s_cmp_lg_u32 s5, 0
    s_cbranch_scc1 L_oq_26
    v_mov_b32 v48, v64
    v_mov_b32 v49, v80
    v_mov_b32 v50, v96
    v_mov_b32 v51, v112
    v_mov_b32 v52, v65
    v_mov_b32 v53, v81
    v_mov_b32 v54, v97
    v_mov_b32 v55, v113
    v_mov_b32 v56, v66
    v_mov_b32 v57, v82
    v_mov_b32 v58, v98
    v_mov_b32 v59, v114
    v_mov_b32 v60, v67
    v_mov_b32 v61, v83
    v_mov_b32 v62, v99
    v_mov_b32 v63, v115
L_oq_26:
    s_cmp_lg_u32 s5, 1
    s_cbranch_scc1 L_oq_27
    v_mov_b32 v48, v68
    v_mov_b32 v49, v84
    v_mov_b32 v50, v100
    v_mov_b32 v51, v116
    v_mov_b32 v52, v69
    v_mov_b32 v53, v85
    v_mov_b32 v54, v101
    v_mov_b32 v55, v117
    v_mov_b32 v56, v70
    v_mov_b32 v57, v86
    v_mov_b32 v58, v102
    v_mov_b32 v59, v118
    v_mov_b32 v60, v71
    v_mov_b32 v61, v87
    v_mov_b32 v62, v103
    v_mov_b32 v63, v119
L_oq_27:
    s_cmp_lg_u32 s5, 2
    s_cbranch_scc1 L_oq_28
    v_mov_b32 v48, v72
    v_mov_b32 v49, v88
    v_mov_b32 v50, v104
    v_mov_b32 v51, v120
    v_mov_b32 v52, v73
    v_mov_b32 v53, v89
    v_mov_b32 v54, v105
    v_mov_b32 v55, v121
    v_mov_b32 v56, v74
    v_mov_b32 v57, v90
    v_mov_b32 v58, v106
    v_mov_b32 v59, v122
    v_mov_b32 v60, v75
    v_mov_b32 v61, v91
    v_mov_b32 v62, v107
    v_mov_b32 v63, v123
L_oq_28:
    s_cmp_lg_u32 s5, 3
    s_cbranch_scc1 L_oq_29
    v_mov_b32 v48, v76
    v_mov_b32 v49, v92
    v_mov_b32 v50, v108
    v_mov_b32 v51, v124
    v_mov_b32 v52, v77
    v_mov_b32 v53, v93
    v_mov_b32 v54, v109
    v_mov_b32 v55, v125
    v_mov_b32 v56, v78
    v_mov_b32 v57, v94
    v_mov_b32 v58, v110
    v_mov_b32 v59, v126
    v_mov_b32 v60, v79
    v_mov_b32 v61, v95
    v_mov_b32 v62, v111
    v_mov_b32 v63, v127
L_oq_29:
    s_waitcnt vmcnt(0)
    s_atomic_add s83, s[78:79], 0 glc
    s_waitcnt lgkmcnt(0)
    s_and_b32 s80, s83, 7
    s_add_u32 s80, s80, 1
L_cpoll:
    s_cmp_eq_u32 s80, 4
    s_cbranch_scc1 L_cready
    s_cmp_eq_u32 s84, 0
    s_cbranch_scc1 L_cgiveup
    s_sub_u32 s84, s84, 1
    s_mov_b32 s80, 0
    s_atomic_add s80, s[78:79], 0 glc
    s_waitcnt lgkmcnt(0)
    s_and_b32 s80, s80, 7
    s_branch L_cpoll
L_cready:
    buffer_load_dwordx2 v[16:17], v15, s[16:19], s73 offen sc1
    buffer_load_dwordx2 v[18:19], v15, s[16:19], s74 offen sc1
    buffer_load_dwordx2 v[20:21], v15, s[16:19], s75 offen sc1
    buffer_load_dwordx4 v[160:163], v9, s[12:15], s70 offen sc1
    buffer_load_dwordx4 v[164:167], v9, s[12:15], s70 offen offset:1024 sc1
    buffer_load_dwordx4 v[168:171], v9, s[12:15], s71 offen sc1
    buffer_load_dwordx4 v[172:175], v9, s[12:15], s71 offen offset:1024 sc1
    buffer_load_dwordx4 v[176:179], v9, s[12:15], s72 offen sc1
    buffer_load_dwordx4 v[180:183], v9, s[12:15], s72 offen offset:1024 sc1
    s_waitcnt vmcnt(0)
L_cfinish:
    v_max3_f32 v6, v16, v18, v20
    v_max_f32 v6, v6, v12
    v_sub_f32 v24, v16, v6
    v_sub_f32 v25, v18, v6
    v_sub_f32 v26, v20, v6
    v_sub_f32 v27, v12, v6
    v_exp_f32 v24, v24
    v_exp_f32 v25, v25
    v_exp_f32 v26, v26
    v_exp_f32 v27, v27
    s_nop 0
    v_mul_f32 v6, v24, v17
    v_fmac_f32 v6, v25, v19
    v_fmac_f32 v6, v26, v21
    v_fmac_f32 v6, v27, v13
    v_rcp_f32 v6, v6
    s_nop 0
    v_mul_f32 v24, v24, v6
    v_mul_f32 v25, v25, v6
    v_mul_f32 v26, v26, v6
    v_mul_f32 v27, v27, v6
    v_mul_f32 v48, v27, v48
    v_mul_f32 v49, v27, v49
    v_mul_f32 v50, v27, v50
    v_mul_f32 v51, v27, v51
    v_mul_f32 v52, v27, v52
    v_mul_f32 v53, v27, v53
    v_mul_f32 v54, v27, v54
    v_mul_f32 v55, v27, v55
    v_mul_f32 v56, v27, v56
    v_mul_f32 v57, v27, v57
    v_mul_f32 v58, v27, v58
    v_mul_f32 v59, v27, v59
    v_mul_f32 v60, v27, v60
    v_mul_f32 v61, v27, v61
    v_mul_f32 v62, v27, v62
    v_mul_f32 v63, v27, v63
    v_lshlrev_b32 v6, 16, v160
    v_and_b32 v7, 0xffff0000, v160
    v_fmac_f32 v48, v24, v6
    v_fmac_f32 v49, v24, v7
    v_lshlrev_b32 v6, 16, v161
    v_and_b32 v7, 0xffff0000, v161
    v_fmac_f32 v50, v24, v6
    v_fmac_f32 v51, v24, v7
    v_lshlrev_b32 v6, 16, v162
    v_and_b32 v7, 0xffff0000, v162
    v_fmac_f32 v52, v24, v6
    v_fmac_f32 v53, v24, v7
    v_lshlrev_b32 v6, 16, v163
    v_and_b32 v7, 0xffff0000, v163
    v_fmac_f32 v54, v24, v6
    v_fmac_f32 v55, v24, v7
    v_lshlrev_b32 v6, 16, v164
    v_and_b32 v7, 0xffff0000, v164
    v_fmac_f32 v56, v24, v6
    v_fmac_f32 v57, v24, v7
    v_lshlrev_b32 v6, 16, v165
    v_and_b32 v7, 0xffff0000, v165
    v_fmac_f32 v58, v24, v6
    v_fmac_f32 v59, v24, v7
    v_lshlrev_b32 v6, 16, v166
    v_and_b32 v7, 0xffff0000, v166
    v_fmac_f32 v60, v24, v6
    v_fmac_f32 v61, v24, v7
    v_lshlrev_b32 v6, 16, v167
    v_and_b32 v7, 0xffff0000, v167
    v_fmac_f32 v62, v24, v6
    v_fmac_f32 v63, v24, v7
    v_lshlrev_b32 v6, 16, v168
    v_and_b32 v7, 0xffff0000, v168
    v_fmac_f32 v48, v25, v6
    v_fmac_f32 v49, v25, v7
    v_lshlrev_b32 v6, 16, v169
    v_and_b32 v7, 0xffff0000, v169
    v_fmac_f32 v50, v25, v6
    v_fmac_f32 v51, v25, v7
    v_lshlrev_b32 v6, 16, v170
    v_and_b32 v7, 0xffff0000, v170
    v_fmac_f32 v52, v25, v6
    v_fmac_f32 v53, v25, v7
    v_lshlrev_b32 v6, 16, v171
    v_and_b32 v7, 0xffff0000, v171
    v_fmac_f32 v54, v25, v6
    v_fmac_f32 v55, v25, v7
    v_lshlrev_b32 v6, 16, v172
    v_and_b32 v7, 0xffff0000, v172
    v_fmac_f32 v56, v25, v6
    v_fmac_f32 v57, v25, v7
    v_lshlrev_b32 v6, 16, v173
    v_and_b32 v7, 0xffff0000, v173
    v_fmac_f32 v58, v25, v6
    v_fmac_f32 v59, v25, v7
    v_lshlrev_b32 v6, 16, v174
    v_and_b32 v7, 0xffff0000, v174
    v_fmac_f32 v60, v25, v6
    v_fmac_f32 v61, v25, v7
    v_lshlrev_b32 v6, 16, v175
    v_and_b32 v7, 0xffff0000, v175
    v_fmac_f32 v62, v25, v6
    v_fmac_f32 v63, v25, v7
    v_lshlrev_b32 v6, 16, v176
    v_and_b32 v7, 0xffff0000, v176
    v_fmac_f32 v48, v26, v6
    v_fmac_f32 v49, v26, v7
    v_lshlrev_b32 v6, 16, v177
    v_and_b32 v7, 0xffff0000, v177
    v_fmac_f32 v50, v26, v6
    v_fmac_f32 v51, v26, v7
    v_lshlrev_b32 v6, 16, v178
    v_and_b32 v7, 0xffff0000, v178
    v_fmac_f32 v52, v26, v6
    v_fmac_f32 v53, v26, v7
    v_lshlrev_b32 v6, 16, v179
    v_and_b32 v7, 0xffff0000, v179
    v_fmac_f32 v54, v26, v6
    v_fmac_f32 v55, v26, v7
    v_lshlrev_b32 v6, 16, v180
    v_and_b32 v7, 0xffff0000, v180
    v_fmac_f32 v56, v26, v6
    v_fmac_f32 v57, v26, v7
    v_lshlrev_b32 v6, 16, v181
    v_and_b32 v7, 0xffff0000, v181
    v_fmac_f32 v58, v26, v6
    v_fmac_f32 v59, v26, v7
    v_lshlrev_b32 v6, 16, v182
    v_and_b32 v7, 0xffff0000, v182
    v_fmac_f32 v60, v26, v6
    v_fmac_f32 v61, v26, v7
    v_lshlrev_b32 v6, 16, v183
    v_and_b32 v7, 0xffff0000, v183
    v_fmac_f32 v62, v26, v6
    v_fmac_f32 v63, v26, v7
    v_cvt_pk_bf16_f32 v32, v48, v49
    v_cvt_pk_bf16_f32 v33, v50, v51
    v_cvt_pk_bf16_f32 v34, v52, v53
    v_cvt_pk_bf16_f32 v35, v54, v55
    v_cvt_pk_bf16_f32 v36, v56, v57
    v_cvt_pk_bf16_f32 v37, v58, v59
    v_cvt_pk_bf16_f32 v38, v60, v61
    v_cvt_pk_bf16_f32 v39, v62, v63
    s_lshl_b32 s80, s5, 6
    s_add_u32 s80, s80, s23
    buffer_store_dwordx4 v[32:35], v28, s[8:11], s80 offen
    buffer_store_dwordx4 v[36:39], v28, s[8:11], s80 offen offset:16
    s_waitcnt lgkmcnt(0)
    s_and_b32 s80, s83, 7
    s_cmp_lg_u32 s80, 3
    s_cbranch_scc1 L_cend
    s_cmp_lg_u32 s3, 0
    s_cbranch_scc1 L_rz_30
    s_mov_b32 s80, 0
    s_atomic_and s80, s[76:77], 0
L_rz_30:
    s_bfe_u32 s85, s83, 0x40004
    s_branch L_cmem
L_cgiveup:
    s_cmp_lg_u32 s5, 0
    s_cbranch_scc1 L_gq_31
    v_cvt_pk_bf16_f32 v128, v64, v80
    v_cvt_pk_bf16_f32 v129, v96, v112
    v_cvt_pk_bf16_f32 v130, v65, v81
    v_cvt_pk_bf16_f32 v131, v97, v113
    v_cvt_pk_bf16_f32 v132, v66, v82
    v_cvt_pk_bf16_f32 v133, v98, v114
    v_cvt_pk_bf16_f32 v134, v67, v83
    v_cvt_pk_bf16_f32 v135, v99, v115
    buffer_store_dwordx4 v[128:131], v9, s[12:15], s21 offen offset:0 sc1
    buffer_store_dwordx4 v[132:135], v9, s[12:15], s21 offen offset:1024 sc1
L_gq_31:
    s_cmp_lg_u32 s5, 1
    s_cbranch_scc1 L_gq_32
    v_cvt_pk_bf16_f32 v136, v68, v84
    v_cvt_pk_bf16_f32 v137, v100, v116
    v_cvt_pk_bf16_f32 v138, v69, v85
    v_cvt_pk_bf16_f32 v139, v101, v117
    v_cvt_pk_bf16_f32 v140, v70, v86
    v_cvt_pk_bf16_f32 v141, v102, v118
    v_cvt_pk_bf16_f32 v142, v71, v87
    v_cvt_pk_bf16_f32 v143, v103, v119
    buffer_store_dwordx4 v[136:139], v9, s[12:15], s21 offen offset:2048 sc1
    buffer_store_dwordx4 v[140:143], v9, s[12:15], s21 offen offset:3072 sc1
L_gq_32:
    s_cmp_lg_u32 s5, 2
    s_cbranch_scc1 L_gq_33
    v_cvt_pk_bf16_f32 v144, v72, v88
    v_cvt_pk_bf16_f32 v145, v104, v120
    v_cvt_pk_bf16_f32 v146, v73, v89
    v_cvt_pk_bf16_f32 v147, v105, v121
    v_cvt_pk_bf16_f32 v148, v74, v90
    v_cvt_pk_bf16_f32 v149, v106, v122
    v_cvt_pk_bf16_f32 v150, v75, v91
    v_cvt_pk_bf16_f32 v151, v107, v123
    buffer_store_dwordx4 v[144:147], v14, s[12:15], s21 offen offset:0 sc1
    buffer_store_dwordx4 v[148:151], v14, s[12:15], s21 offen offset:1024 sc1
L_gq_33:
    s_cmp_lg_u32 s5, 3
    s_cbranch_scc1 L_gq_34
    v_cvt_pk_bf16_f32 v152, v76, v92
    v_cvt_pk_bf16_f32 v153, v108, v124
    v_cvt_pk_bf16_f32 v154, v77, v93
    v_cvt_pk_bf16_f32 v155, v109, v125
    v_cvt_pk_bf16_f32 v156, v78, v94
    v_cvt_pk_bf16_f32 v157, v110, v126
    v_cvt_pk_bf16_f32 v158, v79, v95
    v_cvt_pk_bf16_f32 v159, v111, v127
    buffer_store_dwordx4 v[152:155], v14, s[12:15], s21 offen offset:2048 sc1
    buffer_store_dwordx4 v[156:159], v14, s[12:15], s21 offen offset:3072 sc1
L_gq_34:
    s_waitcnt vmcnt(0)
    s_lshl_b32 s80, 16, s5
    s_atomic_or s80, s[78:79], 0 glc
    s_waitcnt lgkmcnt(0)
    s_and_b32 s80, s80, 7
    s_cmp_lg_u32 s80, 4
    s_cbranch_scc1 L_cend
    s_lshl_b32 s85, 1, s5
L_cmem:
    s_cmp_eq_u32 s85, 0
    s_cbranch_scc1 L_cend
    s_ff1_i32_b32 s86, s85
    s_lshl_b32 s80, 1, s86
    s_andn2_b32 s85, s85, s80
    s_and_b32 s86, s86, 3
    s_lshl_b32 s80, s86, 11
    s_add_u32 s80, s80, s23
    s_mov_b32 s81, s24
    buffer_load_dwordx2 v[16:17], v15, s[16:19], s81 offen sc1
    buffer_load_dwordx4 v[160:163], v9, s[12:15], s80 offen sc1
    buffer_load_dwordx4 v[164:167], v9, s[12:15], s80 offen offset:1024 sc1
    s_add_u32 s80, s80, 0x8000
    s_add_u32 s81, s81, 0x800
    buffer_load_dwordx2 v[18:19], v15, s[16:19], s81 offen sc1
    buffer_load_dwordx4 v[168:171], v9, s[12:15], s80 offen sc1
    buffer_load_dwordx4 v[172:175], v9, s[12:15], s80 offen offset:1024 sc1
    s_add_u32 s80, s80, 0x8000
    s_add_u32 s81, s81, 0x800
    buffer_load_dwordx2 v[20:21], v15, s[16:19], s81 offen sc1
    buffer_load_dwordx4 v[176:179], v9, s[12:15], s80 offen sc1
    buffer_load_dwordx4 v[180:183], v9, s[12:15], s80 offen offset:1024 sc1
    s_add_u32 s80, s80, 0x8000
    s_add_u32 s81, s81, 0x800
    buffer_load_dwordx2 v[22:23], v15, s[16:19], s81 offen sc1
    buffer_load_dwordx4 v[184:187], v9, s[12:15], s80 offen sc1
    buffer_load_dwordx4 v[188:191], v9, s[12:15], s80 offen offset:1024 sc1
    s_add_u32 s80, s80, 0x8000
    s_add_u32 s81, s81, 0x800
    s_waitcnt vmcnt(0)
    v_max3_f32 v6, v16, v18, v20
    v_max_f32 v6, v6, v22
    v_sub_f32 v24, v16, v6
    v_sub_f32 v25, v18, v6
    v_sub_f32 v26, v20, v6
    v_sub_f32 v27, v22, v6
    v_exp_f32 v24, v24
    v_exp_f32 v25, v25
    v_exp_f32 v26, v26
    v_exp_f32 v27, v27
    s_nop 0
    v_mul_f32 v6, v24, v17
    v_fmac_f32 v6, v25, v19
    v_fmac_f32 v6, v26, v21
    v_fmac_f32 v6, v27, v23
    v_rcp_f32 v6, v6
    s_nop 0
    v_mul_f32 v24, v24, v6
    v_mul_f32 v25, v25, v6
    v_mul_f32 v26, v26, v6
    v_mul_f32 v27, v27, v6
    v_lshlrev_b32 v6, 16, v160
    v_and_b32 v7, 0xffff0000, v160
    v_mul_f32 v48, v24, v6
    v_mul_f32 v49, v24, v7
    v_lshlrev_b32 v6, 16, v161
    v_and_b32 v7, 0xffff0000, v161
    v_mul_f32 v50, v24, v6
    v_mul_f32 v51, v24, v7
    v_lshlrev_b32 v6, 16, v162
    v_and_b32 v7, 0xffff0000, v162
    v_mul_f32 v52, v24, v6
    v_mul_f32 v53, v24, v7
    v_lshlrev_b32 v6, 16, v163
    v_and_b32 v7, 0xffff0000, v163
    v_mul_f32 v54, v24, v6
    v_mul_f32 v55, v24, v7
    v_lshlrev_b32 v6, 16, v164
    v_and_b32 v7, 0xffff0000, v164
    v_mul_f32 v56, v24, v6
    v_mul_f32 v57, v24, v7
    v_lshlrev_b32 v6, 16, v165
    v_and_b32 v7, 0xffff0000, v165
    v_mul_f32 v58, v24, v6
    v_mul_f32 v59, v24, v7
    v_lshlrev_b32 v6, 16, v166
    v_and_b32 v7, 0xffff0000, v166
    v_mul_f32 v60, v24, v6
    v_mul_f32 v61, v24, v7
    v_lshlrev_b32 v6, 16, v167
    v_and_b32 v7, 0xffff0000, v167
    v_mul_f32 v62, v24, v6
    v_mul_f32 v63, v24, v7
    v_lshlrev_b32 v6, 16, v168
    v_and_b32 v7, 0xffff0000, v168
    v_fmac_f32 v48, v25, v6
    v_fmac_f32 v49, v25, v7
    v_lshlrev_b32 v6, 16, v169
    v_and_b32 v7, 0xffff0000, v169
    v_fmac_f32 v50, v25, v6
    v_fmac_f32 v51, v25, v7
    v_lshlrev_b32 v6, 16, v170
    v_and_b32 v7, 0xffff0000, v170
    v_fmac_f32 v52, v25, v6
    v_fmac_f32 v53, v25, v7
    v_lshlrev_b32 v6, 16, v171
    v_and_b32 v7, 0xffff0000, v171
    v_fmac_f32 v54, v25, v6
    v_fmac_f32 v55, v25, v7
    v_lshlrev_b32 v6, 16, v172
    v_and_b32 v7, 0xffff0000, v172
    v_fmac_f32 v56, v25, v6
    v_fmac_f32 v57, v25, v7
    v_lshlrev_b32 v6, 16, v173
    v_and_b32 v7, 0xffff0000, v173
    v_fmac_f32 v58, v25, v6
    v_fmac_f32 v59, v25, v7
    v_lshlrev_b32 v6, 16, v174
    v_and_b32 v7, 0xffff0000, v174
    v_fmac_f32 v60, v25, v6
    v_fmac_f32 v61, v25, v7
    v_lshlrev_b32 v6, 16, v175
    v_and_b32 v7, 0xffff0000, v175
    v_fmac_f32 v62, v25, v6
    v_fmac_f32 v63, v25, v7
    v_lshlrev_b32 v6, 16, v176
    v_and_b32 v7, 0xffff0000, v176
    v_fmac_f32 v48, v26, v6
    v_fmac_f32 v49, v26, v7
    v_lshlrev_b32 v6, 16, v177
    v_and_b32 v7, 0xffff0000, v177
    v_fmac_f32 v50, v26, v6
    v_fmac_f32 v51, v26, v7
    v_lshlrev_b32 v6, 16, v178
    v_and_b32 v7, 0xffff0000, v178
    v_fmac_f32 v52, v26, v6
    v_fmac_f32 v53, v26, v7
    v_lshlrev_b32 v6, 16, v179
    v_and_b32 v7, 0xffff0000, v179
    v_fmac_f32 v54, v26, v6
    v_fmac_f32 v55, v26, v7
    v_lshlrev_b32 v6, 16, v180
    v_and_b32 v7, 0xffff0000, v180
    v_fmac_f32 v56, v26, v6
    v_fmac_f32 v57, v26, v7
    v_lshlrev_b32 v6, 16, v181
    v_and_b32 v7, 0xffff0000, v181
    v_fmac_f32 v58, v26, v6
    v_fmac_f32 v59, v26, v7
    v_lshlrev_b32 v6, 16, v182
    v_and_b32 v7, 0xffff0000, v182
    v_fmac_f32 v60, v26, v6
    v_fmac_f32 v61, v26, v7
    v_lshlrev_b32 v6, 16, v183
    v_and_b32 v7, 0xffff0000, v183
    v_fmac_f32 v62, v26, v6
    v_fmac_f32 v63, v26, v7
    v_lshlrev_b32 v6, 16, v184
    v_and_b32 v7, 0xffff0000, v184
    v_fmac_f32 v48, v27, v6
    v_fmac_f32 v49, v27, v7
    v_lshlrev_b32 v6, 16, v185
    v_and_b32 v7, 0xffff0000, v185
    v_fmac_f32 v50, v27, v6
    v_fmac_f32 v51, v27, v7
    v_lshlrev_b32 v6, 16, v186
    v_and_b32 v7, 0xffff0000, v186
    v_fmac_f32 v52, v27, v6
    v_fmac_f32 v53, v27, v7
    v_lshlrev_b32 v6, 16, v187
    v_and_b32 v7, 0xffff0000, v187
    v_fmac_f32 v54, v27, v6
    v_fmac_f32 v55, v27, v7
    v_lshlrev_b32 v6, 16, v188
    v_and_b32 v7, 0xffff0000, v188
    v_fmac_f32 v56, v27, v6
    v_fmac_f32 v57, v27, v7
    v_lshlrev_b32 v6, 16, v189
    v_and_b32 v7, 0xffff0000, v189
    v_fmac_f32 v58, v27, v6
    v_fmac_f32 v59, v27, v7
    v_lshlrev_b32 v6, 16, v190
    v_and_b32 v7, 0xffff0000, v190
    v_fmac_f32 v60, v27, v6
    v_fmac_f32 v61, v27, v7
    v_lshlrev_b32 v6, 16, v191
    v_and_b32 v7, 0xffff0000, v191
    v_fmac_f32 v62, v27, v6
    v_fmac_f32 v63, v27, v7
    v_cvt_pk_bf16_f32 v32, v48, v49
    v_cvt_pk_bf16_f32 v33, v50, v51
    v_cvt_pk_bf16_f32 v34, v52, v53
    v_cvt_pk_bf16_f32 v35, v54, v55
    v_cvt_pk_bf16_f32 v36, v56, v57
    v_cvt_pk_bf16_f32 v37, v58, v59
    v_cvt_pk_bf16_f32 v38, v60, v61
    v_cvt_pk_bf16_f32 v39, v62, v63
    s_lshl_b32 s80, s86, 6
    s_add_u32 s80, s80, s23
    buffer_store_dwordx4 v[32:35], v28, s[8:11], s80 offen
    buffer_store_dwordx4 v[36:39], v28, s[8:11], s80 offen offset:16
    s_branch L_cmem
L_cend:
    s_endpgm
L_exit:
    s_endpgm
.section .rodata,"a"
.p2align 6
.amdhsa_kernel standalone__kv_cache_quant_int4_int2_kv_with_per_channel_or_per_token_scales__sampling_kernel
  .amdhsa_next_free_vgpr 256
  .amdhsa_next_free_sgpr 102
  .amdhsa_accum_offset 256
  .amdhsa_group_segment_fixed_size 0
  .amdhsa_kernarg_size 80
  .amdhsa_user_sgpr_count 2
  .amdhsa_user_sgpr_kernarg_segment_ptr 1
  .amdhsa_system_sgpr_workgroup_id_x 1
  .amdhsa_float_denorm_mode_32 3
.end_amdhsa_kernel
```
